```python
import torch

def _softmax(x, axis=-1):
    return torch.softmax(x, dim=axis)
def _gelu(x):
    return torch.nn.functional.gelu(x, approximate="tanh")
def _silu(x):
    return torch.nn.functional.silu(x)
def _sigmoid(x):
    return torch.sigmoid(x)
def _layernorm(x, axis=-1, eps=1e-5):
    m = x.mean(dim=axis, keepdim=True)
    v = x.var(dim=axis, keepdim=True, unbiased=False)
    return (x - m) / torch.sqrt(v + eps)
def _scatter_add(tgt, idx, src, axis=0):
    return tgt.clone().index_add_(axis, idx, src)
def _segment_sum(src, seg, n):
    out = torch.zeros((n,) + src.shape[1:], dtype=src.dtype)
    return out.index_add_(0, seg, src)
def _pad(x, pw):
    flat = tuple(v for pair in reversed(pw) for v in pair)
    return torch.nn.functional.pad(x, flat)

kernel_name = 'standalone__weight_only_int_omniquant__prompt'

def setup_inputs():

    _w = (lambda a: (lambda t: t.to(torch.bfloat16) if t.is_floating_point() else t)(torch.as_tensor(a)))
    B, S, D, F = 1, 2048, 1024, 3584
    bits = 3
    G = 64 if 64 > 0 else D
    D = (D // G) * G
    ng = D // G
    qmax = (1 << bits) - 1
    qw = torch.randint(0, qmax + 1, (D, F)).to(torch.int32)
    scales = (torch.abs((lambda *s: torch.randn(*s, dtype=torch.bfloat16) * 0.05)(ng, F)) * 0.05 + 0.01).to(float)
    zeros = torch.randint(0, qmax + 1, (ng, F)).to(float)
    act_scale = (torch.abs((lambda *s: torch.randn(*s, dtype=torch.bfloat16) * 0.05)(D)) * 0.5 + 0.5).to(float)
    return {
        "x": _w((lambda *s: torch.randn(*s, dtype=torch.bfloat16) * 0.05)(B, S, D)),
        "qw": _w(qw),
        "scales": _w(scales),
        "zeros": _w(zeros),
        "act_scale": _w(act_scale),
    }

def reference(x, qw, scales, zeros, act_scale):
    B, S, D = x.shape
    ng, F = scales.shape
    G = D // ng
    s = (lambda x, n, axis: torch.repeat_interleave(x, n, dim=axis))(scales, G, axis=0)
    z = (lambda x, n, axis: torch.repeat_interleave(x, n, dim=axis))(zeros, G, axis=0)
    w = ((lambda x, dt: x.to(dt))(qw, x.dtype) - z) * s
    xs = x * (lambda x, dt: x.to(dt))(act_scale, x.dtype)
    return torch.einsum("bsd,df->bsf", xs, w)
```

```asm
; @launch grid=(256,1,1) block=(512,1,1) lds=147520
.amdgcn_target "amdgcn-amd-amdhsa--gfx950"
.text
.globl standalone__weight_only_int_omniquant__prompt_kernel
.p2align 8
.type standalone__weight_only_int_omniquant__prompt_kernel,@function
standalone__weight_only_int_omniquant__prompt_kernel:
    s_cmp_ge_u32 s2, 256
    s_cbranch_scc1 L_end
    s_cmp_ge_u32 s2, 224
    s_cbranch_scc1 L_helper
    s_load_dwordx4 s[68:71], s[0:1], 0
    s_load_dwordx4 s[72:75], s[0:1], 16
    s_load_dwordx4 s[76:79], s[0:1], 32
    s_load_dwordx4 s[80:83], s[0:1], 48
    v_lshrrev_b32 v1, 6, v0
    v_and_b32 v0, 63, v0
    v_readfirstlane_b32 s30, v1
    s_and_b32 s35, s2, 7
    s_lshr_b32 s36, s2, 3
    s_mul_i32 s35, s35, 28
    s_add_u32 s35, s35, s36
    s_lshr_b32 s29, s35, 3
    s_and_b32 s28, s35, 7
    s_lshl_b32 s31, s28, 1
    s_and_b32 s41, s30, 3
    v_mov_b32 v254, v0
    s_cmp_lt_u32 s30, 4
    s_cbranch_scc1 L_consumer
L_loader:
    v_lshrrev_b32 v89, 5, v254
    v_and_b32 v84, 31, v254
    s_lshl_b32 s35, s41, 1
    v_add_u32 v83, s35, v89
    s_mov_b32 s35, 114688
    v_mul_lo_u32 v80, s35, v83
    v_lshl_add_u32 v80, v84, 4, v80
    s_mul_i32 s35, s31, 917504
    s_lshl_b32 s36, s29, 9
    s_add_u32 s35, s35, s36
    v_lshlrev_b32 v105, 7, v254
    s_lshl_b32 s100, s29, 10
    s_add_u32 s100, s100, 8388608
    s_waitcnt lgkmcnt(0)
    s_mov_b32 s88, s82
    s_and_b32 s89, s83, 0xffff
    s_mov_b32 s90, 8417280
    s_mov_b32 s91, 0x20000
    s_mov_b64 exec, 0xff
    buffer_load_dword v106, v105, s[88:91], s100 offen sc1
    s_mov_b64 exec, -1
    s_mov_b32 s8, s70
    s_and_b32 s9, s71, 0xffff
    s_mov_b32 s10, 14680064
    s_mov_b32 s11, 0x20000
    buffer_load_dwordx4 v[0:3], v80, s[8:11], s35 offen nt
    s_add_u32 s35, s35, 14336
    buffer_load_dwordx4 v[4:7], v80, s[8:11], s35 offen nt
    s_add_u32 s35, s35, 14336
    buffer_load_dwordx4 v[8:11], v80, s[8:11], s35 offen nt
    s_add_u32 s35, s35, 14336
    buffer_load_dwordx4 v[12:15], v80, s[8:11], s35 offen nt
    s_add_u32 s35, s35, 14336
    buffer_load_dwordx4 v[16:19], v80, s[8:11], s35 offen nt
    s_add_u32 s35, s35, 14336
    buffer_load_dwordx4 v[20:23], v80, s[8:11], s35 offen nt
    s_add_u32 s35, s35, 14336
    buffer_load_dwordx4 v[24:27], v80, s[8:11], s35 offen nt
    s_add_u32 s35, s35, 14336
    buffer_load_dwordx4 v[28:31], v80, s[8:11], s35 offen nt
    s_add_u32 s35, s35, 14336
    v_lshlrev_b32 v81, 3, v84
    v_lshlrev_b32 v82, 4, v83
    s_mul_i32 s37, s31, 7168
    s_lshl_b32 s36, s29, 8
    s_add_u32 s37, s37, s36
    s_lshl_b32 s38, s31, 7
    s_mov_b32 s12, s72
    s_and_b32 s13, s73, 0xffff
    s_mov_b32 s14, 114688
    s_mov_b32 s15, 0x20000
    s_mov_b32 s16, s74
    s_and_b32 s17, s75, 0xffff
    s_mov_b32 s18, 114688
    s_mov_b32 s19, 0x20000
    s_mov_b32 s20, s76
    s_and_b32 s21, s77, 0xffff
    s_mov_b32 s22, 2048
    s_mov_b32 s23, 0x20000
    buffer_load_dwordx2 v[32:33], v81, s[12:15], s37 offen
    buffer_load_dwordx2 v[34:35], v81, s[16:19], s37 offen
    buffer_load_dwordx4 v[36:39], v82, s[20:23], s38 offen
    v_lshrrev_b32 v89, 3, v254
    v_and_b32 v90, 7, v254
    v_lshrrev_b32 v91, 1, v89
    v_xor_b32 v90, v90, v91
    v_lshlrev_b32 v90, 4, v90
    v_lshl_add_u32 v90, v89, 11, v90
    v_xor_b32 v91, 64, v90
    s_mov_b32 s4, s68
    s_and_b32 s5, s69, 0xffff
    s_mov_b32 s6, 4194304
    s_mov_b32 s7, 0x20000
    v_add_u32 v96, 0, v90
    v_add_u32 v97, 15360, v91
    v_add_u32 v98, 30720, v90
    v_add_u32 v99, 46080, v91
    v_add_u32 v100, 65536, v90
    v_add_u32 v101, 80896, v91
    v_add_u32 v102, 96256, v90
    v_add_u32 v103, 111616, v91
    v_lshlrev_b32 v104, 4, v254
    s_lshl_b32 s36, s28, 8
    s_lshl_b32 s39, s41, 6
    s_add_u32 s36, s36, s39
    s_lshl_b32 s33, s36, 11
    s_lshl_b32 s34, s41, 13
    s_lshl_b32 s45, s31, 7
    s_add_u32 s45, s45, s33
    s_mov_b32 s46, s34
    s_add_u32 m0, s46, 0
    s_nop 0
    buffer_load_dwordx4 v96, s[4:7], s45 offen offset:0  lds
    buffer_load_dwordx4 v97, s[4:7], s45 offen offset:1024  lds
    buffer_load_dwordx4 v98, s[4:7], s45 offen offset:2048  lds
    buffer_load_dwordx4 v99, s[4:7], s45 offen offset:3072  lds
    s_add_u32 m0, s46, 4096
    s_nop 0
    buffer_load_dwordx4 v100, s[4:7], s45 offen offset:0  lds
    buffer_load_dwordx4 v101, s[4:7], s45 offen offset:1024  lds
    buffer_load_dwordx4 v102, s[4:7], s45 offen offset:2048  lds
    buffer_load_dwordx4 v103, s[4:7], s45 offen offset:3072  lds
    s_add_u32 s97, s35, 802816
    s_add_u32 s98, s37, 7168
    s_add_u32 s99, s38, 128
    v_lshrrev_b32 v89, 3, v84
    v_lshlrev_b32 v89, 5, v89
    v_and_b32 v90, 1, v84
    v_lshl_add_u32 v89, v90, 4, v89
    v_bfe_u32 v90, v84, 1, 2
    v_lshl_add_u32 v89, v90, 2, v89
    v_add_u32 v90, 0, v89
    v_bfe_u32 v91, v90, 1, 3
    v_bfe_u32 v92, v90, 4, 1
    v_xor_b32 v91, v91, v92
    v_xor_b32 v91, v91, v83
    v_lshlrev_b32 v91, 4, v91
    v_lshl_add_u32 v85, v90, 7, v91
    v_add_u32 v85, 32768, v85
    v_add_u32 v90, 1, v89
    v_bfe_u32 v91, v90, 1, 3
    v_bfe_u32 v92, v90, 4, 1
    v_xor_b32 v91, v91, v92
    v_xor_b32 v91, v91, v83
    v_lshlrev_b32 v91, 4, v91
    v_lshl_add_u32 v86, v90, 7, v91
    v_add_u32 v86, 32768, v86
    v_add_u32 v90, 2, v89
    v_bfe_u32 v91, v90, 1, 3
    v_bfe_u32 v92, v90, 4, 1
    v_xor_b32 v91, v91, v92
    v_xor_b32 v91, v91, v83
    v_lshlrev_b32 v91, 4, v91
    v_lshl_add_u32 v87, v90, 7, v91
    v_add_u32 v87, 32768, v87
    v_add_u32 v90, 3, v89
    v_bfe_u32 v91, v90, 1, 3
    v_bfe_u32 v92, v90, 4, 1
    v_xor_b32 v91, v91, v92
    v_xor_b32 v91, v91, v83
    v_lshlrev_b32 v91, 4, v91
    v_lshl_add_u32 v88, v90, 7, v91
    v_add_u32 v88, 32768, v88
    s_mov_b32 s40, 0x4b800000
    v_mov_b32 v108, 0
    s_mul_i32 s43, s29, 262144
    s_lshl_b32 s35, s41, 12
    s_add_u32 s43, s43, s35
    v_add_u32 v93, s35, v104
    v_add_u32 v93, 32768, v93
    v_add_u32 v94, 49152, v93
    v_add_u32 v109, 49152, v85
    v_add_u32 v110, 49152, v86
    v_add_u32 v111, 49152, v87
    v_add_u32 v95, 49152, v88
    s_add_u32 s36, s97, 0
    buffer_load_dwordx4 v[112:115], v80, s[8:11], s36 offen nt
    s_add_u32 s36, s97, 14336
    buffer_load_dwordx4 v[116:119], v80, s[8:11], s36 offen nt
    s_add_u32 s36, s97, 28672
    buffer_load_dwordx4 v[120:123], v80, s[8:11], s36 offen nt
    s_add_u32 s36, s97, 43008
    buffer_load_dwordx4 v[124:127], v80, s[8:11], s36 offen nt
    s_add_u32 s36, s97, 57344
    buffer_load_dwordx4 v[128:131], v80, s[8:11], s36 offen nt
    s_add_u32 s36, s97, 71680
    buffer_load_dwordx4 v[132:135], v80, s[8:11], s36 offen nt
    s_add_u32 s36, s97, 86016
    buffer_load_dwordx4 v[136:139], v80, s[8:11], s36 offen nt
    s_add_u32 s36, s97, 100352
    buffer_load_dwordx4 v[140:143], v80, s[8:11], s36 offen nt
    buffer_load_dwordx2 v[144:145], v81, s[12:15], s98 offen
    buffer_load_dwordx2 v[146:147], v81, s[16:19], s98 offen
    buffer_load_dwordx4 v[148:151], v82, s[20:23], s99 offen
    s_waitcnt vmcnt(19)
    v_lshlrev_b32 v40, 16, v32
    v_lshlrev_b32 v44, 16, v34
    v_and_b32 v41, 0xffff0000, v32
    v_and_b32 v45, 0xffff0000, v34
    v_lshlrev_b32 v42, 16, v33
    v_lshlrev_b32 v46, 16, v35
    v_and_b32 v43, 0xffff0000, v33
    v_and_b32 v47, 0xffff0000, v35
    v_mul_f32 v44, -v44, v40
    v_mul_f32 v45, -v45, v41
    v_mul_f32 v46, -v46, v42
    v_mul_f32 v47, -v47, v43
    v_mul_f32 v40, s40, v40
    v_mul_f32 v41, s40, v41
    v_mul_f32 v42, s40, v42
    v_mul_f32 v43, s40, v43
    v_lshlrev_b32 v48, 16, v36
    v_and_b32 v49, 0xffff0000, v36
    v_lshlrev_b32 v50, 16, v37
    v_and_b32 v51, 0xffff0000, v37
    v_lshlrev_b32 v52, 16, v38
    v_and_b32 v53, 0xffff0000, v38
    v_lshlrev_b32 v54, 16, v39
    v_and_b32 v55, 0xffff0000, v39
    v_fma_mix_f32 v56, v0, v40, v44 op_sel_hi:[1,0,0]
    v_fma_mix_f32 v57, v4, v40, v44 op_sel_hi:[1,0,0]
    v_fma_mix_f32 v58, v8, v40, v44 op_sel_hi:[1,0,0]
    v_fma_mix_f32 v59, v12, v40, v44 op_sel_hi:[1,0,0]
    v_fma_mix_f32 v60, v16, v40, v44 op_sel_hi:[1,0,0]
    v_fma_mix_f32 v61, v20, v40, v44 op_sel_hi:[1,0,0]
    v_fma_mix_f32 v62, v24, v40, v44 op_sel_hi:[1,0,0]
    v_fma_mix_f32 v63, v28, v40, v44 op_sel_hi:[1,0,0]
    v_mul_f32 v56, v56, v48
    v_mul_f32 v57, v57, v49
    v_mul_f32 v58, v58, v50
    v_mul_f32 v59, v59, v51
    v_mul_f32 v60, v60, v52
    v_mul_f32 v61, v61, v53
    v_mul_f32 v62, v62, v54
    v_mul_f32 v63, v63, v55
    v_cvt_pk_bf16_f32 v64, v56, v57
    v_cvt_pk_bf16_f32 v65, v58, v59
    v_cvt_pk_bf16_f32 v66, v60, v61
    v_cvt_pk_bf16_f32 v67, v62, v63
    ds_write_b128 v85, v[64:67] offset:0
    v_fma_mix_f32 v56, v1, v41, v45 op_sel_hi:[1,0,0]
    v_fma_mix_f32 v57, v5, v41, v45 op_sel_hi:[1,0,0]
    v_fma_mix_f32 v58, v9, v41, v45 op_sel_hi:[1,0,0]
    v_fma_mix_f32 v59, v13, v41, v45 op_sel_hi:[1,0,0]
    v_fma_mix_f32 v60, v17, v41, v45 op_sel_hi:[1,0,0]
    v_fma_mix_f32 v61, v21, v41, v45 op_sel_hi:[1,0,0]
    v_fma_mix_f32 v62, v25, v41, v45 op_sel_hi:[1,0,0]
    v_fma_mix_f32 v63, v29, v41, v45 op_sel_hi:[1,0,0]
    v_mul_f32 v56, v56, v48
    v_mul_f32 v57, v57, v49
    v_mul_f32 v58, v58, v50
    v_mul_f32 v59, v59, v51
    v_mul_f32 v60, v60, v52
    v_mul_f32 v61, v61, v53
    v_mul_f32 v62, v62, v54
    v_mul_f32 v63, v63, v55
    v_cvt_pk_bf16_f32 v68, v56, v57
    v_cvt_pk_bf16_f32 v69, v58, v59
    v_cvt_pk_bf16_f32 v70, v60, v61
    v_cvt_pk_bf16_f32 v71, v62, v63
    ds_write_b128 v86, v[68:71] offset:0
    v_fma_mix_f32 v56, v2, v42, v46 op_sel_hi:[1,0,0]
    v_fma_mix_f32 v57, v6, v42, v46 op_sel_hi:[1,0,0]
    v_fma_mix_f32 v58, v10, v42, v46 op_sel_hi:[1,0,0]
    v_fma_mix_f32 v59, v14, v42, v46 op_sel_hi:[1,0,0]
    v_fma_mix_f32 v60, v18, v42, v46 op_sel_hi:[1,0,0]
    v_fma_mix_f32 v61, v22, v42, v46 op_sel_hi:[1,0,0]
    v_fma_mix_f32 v62, v26, v42, v46 op_sel_hi:[1,0,0]
    v_fma_mix_f32 v63, v30, v42, v46 op_sel_hi:[1,0,0]
    v_mul_f32 v56, v56, v48
    v_mul_f32 v57, v57, v49
    v_mul_f32 v58, v58, v50
    v_mul_f32 v59, v59, v51
    v_mul_f32 v60, v60, v52
    v_mul_f32 v61, v61, v53
    v_mul_f32 v62, v62, v54
    v_mul_f32 v63, v63, v55
    v_cvt_pk_bf16_f32 v72, v56, v57
    v_cvt_pk_bf16_f32 v73, v58, v59
    v_cvt_pk_bf16_f32 v74, v60, v61
    v_cvt_pk_bf16_f32 v75, v62, v63
    ds_write_b128 v87, v[72:75] offset:0
    v_fma_mix_f32 v56, v3, v43, v47 op_sel_hi:[1,0,0]
    v_fma_mix_f32 v57, v7, v43, v47 op_sel_hi:[1,0,0]
    v_fma_mix_f32 v58, v11, v43, v47 op_sel_hi:[1,0,0]
    v_fma_mix_f32 v59, v15, v43, v47 op_sel_hi:[1,0,0]
    v_fma_mix_f32 v60, v19, v43, v47 op_sel_hi:[1,0,0]
    v_fma_mix_f32 v61, v23, v43, v47 op_sel_hi:[1,0,0]
    v_fma_mix_f32 v62, v27, v43, v47 op_sel_hi:[1,0,0]
    v_fma_mix_f32 v63, v31, v43, v47 op_sel_hi:[1,0,0]
    v_mul_f32 v56, v56, v48
    v_mul_f32 v57, v57, v49
    v_mul_f32 v58, v58, v50
    v_mul_f32 v59, v59, v51
    v_mul_f32 v60, v60, v52
    v_mul_f32 v61, v61, v53
    v_mul_f32 v62, v62, v54
    v_mul_f32 v63, v63, v55
    v_cvt_pk_bf16_f32 v76, v56, v57
    v_cvt_pk_bf16_f32 v77, v58, v59
    v_cvt_pk_bf16_f32 v78, v60, v61
    v_cvt_pk_bf16_f32 v79, v62, v63
    ds_write_b128 v88, v[76:79] offset:0
    s_waitcnt vmcnt(11) lgkmcnt(0)
    s_barrier
    ds_read_b128 v[0:3], v93 offset:0
    ds_read_b128 v[4:7], v93 offset:1024
    ds_read_b128 v[8:11], v93 offset:2048
    ds_read_b128 v[12:15], v93 offset:3072
    s_add_u32 s36, s31, 0
    s_lshl_b32 s36, s36, 14
    s_add_u32 s36, s36, s43
    s_waitcnt lgkmcnt(3)
    buffer_store_dwordx4 v[0:3], v104, s[88:91], s36 offen offset:0 sc1
    s_waitcnt lgkmcnt(2)
    buffer_store_dwordx4 v[4:7], v104, s[88:91], s36 offen offset:1024 sc1
    s_waitcnt lgkmcnt(1)
    buffer_store_dwordx4 v[8:11], v104, s[88:91], s36 offen offset:2048 sc1
    s_waitcnt lgkmcnt(0)
    buffer_store_dwordx4 v[12:15], v104, s[88:91], s36 offen offset:3072 sc1
    s_add_u32 s36, s31, 1
    s_lshl_b32 s45, s36, 7
    s_add_u32 s45, s45, s33
    s_add_u32 m0, s34, 49152
    s_nop 0
    buffer_load_dwordx4 v96, s[4:7], s45 offen offset:0  lds
    buffer_load_dwordx4 v97, s[4:7], s45 offen offset:1024  lds
    buffer_load_dwordx4 v98, s[4:7], s45 offen offset:2048  lds
    buffer_load_dwordx4 v99, s[4:7], s45 offen offset:3072  lds
    s_add_u32 m0, s34, 53248
    s_nop 0
    buffer_load_dwordx4 v100, s[4:7], s45 offen offset:0  lds
    buffer_load_dwordx4 v101, s[4:7], s45 offen offset:1024  lds
    buffer_load_dwordx4 v102, s[4:7], s45 offen offset:2048  lds
    buffer_load_dwordx4 v103, s[4:7], s45 offen offset:3072  lds
    s_waitcnt vmcnt(8)
    v_mov_b32 v90, 147456
    v_mov_b32 v91, 1
    s_mov_b64 exec, 1
    ds_add_rtn_u32 v92, v90, v91
    s_waitcnt lgkmcnt(0)
    s_mov_b64 exec, -1
    v_readfirstlane_b32 s38, v92
    s_nop 3
    s_cmp_eq_u32 s38, 3
    s_cselect_b32 s38, 1, 0
    s_lshl_b32 s37, s28, 7
    s_add_u32 s37, s37, s100
    s_cmp_eq_u32 s38, 1
    s_cselect_b32 s37, s37, 0x7ff00000
    v_readlane_b32 s36, v106, s28
    s_nop 3
    s_add_u32 s36, s36, 1
    v_mov_b32 v91, s36
    v_mov_b32 v92, 0
    s_mov_b64 exec, 1
    buffer_store_dword v91, v92, s[88:91], s37 offen sc1
    s_mov_b64 exec, -1
    s_waitcnt vmcnt(13)
    v_lshlrev_b32 v40, 16, v144
    v_lshlrev_b32 v44, 16, v146
    v_and_b32 v41, 0xffff0000, v144
    v_and_b32 v45, 0xffff0000, v146
    v_lshlrev_b32 v42, 16, v145
    v_lshlrev_b32 v46, 16, v147
    v_and_b32 v43, 0xffff0000, v145
    v_and_b32 v47, 0xffff0000, v147
    v_mul_f32 v44, -v44, v40
    v_mul_f32 v45, -v45, v41
    v_mul_f32 v46, -v46, v42
    v_mul_f32 v47, -v47, v43
    v_mul_f32 v40, s40, v40
    v_mul_f32 v41, s40, v41
    v_mul_f32 v42, s40, v42
    v_mul_f32 v43, s40, v43
    v_lshlrev_b32 v48, 16, v148
    v_and_b32 v49, 0xffff0000, v148
    v_lshlrev_b32 v50, 16, v149
    v_and_b32 v51, 0xffff0000, v149
    v_lshlrev_b32 v52, 16, v150
    v_and_b32 v53, 0xffff0000, v150
    v_lshlrev_b32 v54, 16, v151
    v_and_b32 v55, 0xffff0000, v151
    v_fma_mix_f32 v56, v112, v40, v44 op_sel_hi:[1,0,0]
    v_fma_mix_f32 v57, v116, v40, v44 op_sel_hi:[1,0,0]
    v_fma_mix_f32 v58, v120, v40, v44 op_sel_hi:[1,0,0]
    v_fma_mix_f32 v59, v124, v40, v44 op_sel_hi:[1,0,0]
    v_fma_mix_f32 v60, v128, v40, v44 op_sel_hi:[1,0,0]
    v_fma_mix_f32 v61, v132, v40, v44 op_sel_hi:[1,0,0]
    v_fma_mix_f32 v62, v136, v40, v44 op_sel_hi:[1,0,0]
    v_fma_mix_f32 v63, v140, v40, v44 op_sel_hi:[1,0,0]
    v_mul_f32 v56, v56, v48
    v_mul_f32 v57, v57, v49
    v_mul_f32 v58, v58, v50
    v_mul_f32 v59, v59, v51
    v_mul_f32 v60, v60, v52
    v_mul_f32 v61, v61, v53
    v_mul_f32 v62, v62, v54
    v_mul_f32 v63, v63, v55
    v_cvt_pk_bf16_f32 v64, v56, v57
    v_cvt_pk_bf16_f32 v65, v58, v59
    v_cvt_pk_bf16_f32 v66, v60, v61
    v_cvt_pk_bf16_f32 v67, v62, v63
    ds_write_b128 v109, v[64:67] offset:0
    v_fma_mix_f32 v56, v113, v41, v45 op_sel_hi:[1,0,0]
    v_fma_mix_f32 v57, v117, v41, v45 op_sel_hi:[1,0,0]
    v_fma_mix_f32 v58, v121, v41, v45 op_sel_hi:[1,0,0]
    v_fma_mix_f32 v59, v125, v41, v45 op_sel_hi:[1,0,0]
    v_fma_mix_f32 v60, v129, v41, v45 op_sel_hi:[1,0,0]
    v_fma_mix_f32 v61, v133, v41, v45 op_sel_hi:[1,0,0]
    v_fma_mix_f32 v62, v137, v41, v45 op_sel_hi:[1,0,0]
    v_fma_mix_f32 v63, v141, v41, v45 op_sel_hi:[1,0,0]
    v_mul_f32 v56, v56, v48
    v_mul_f32 v57, v57, v49
    v_mul_f32 v58, v58, v50
    v_mul_f32 v59, v59, v51
    v_mul_f32 v60, v60, v52
    v_mul_f32 v61, v61, v53
    v_mul_f32 v62, v62, v54
    v_mul_f32 v63, v63, v55
    v_cvt_pk_bf16_f32 v68, v56, v57
    v_cvt_pk_bf16_f32 v69, v58, v59
    v_cvt_pk_bf16_f32 v70, v60, v61
    v_cvt_pk_bf16_f32 v71, v62, v63
    ds_write_b128 v110, v[68:71] offset:0
    v_fma_mix_f32 v56, v114, v42, v46 op_sel_hi:[1,0,0]
    v_fma_mix_f32 v57, v118, v42, v46 op_sel_hi:[1,0,0]
    v_fma_mix_f32 v58, v122, v42, v46 op_sel_hi:[1,0,0]
    v_fma_mix_f32 v59, v126, v42, v46 op_sel_hi:[1,0,0]
    v_fma_mix_f32 v60, v130, v42, v46 op_sel_hi:[1,0,0]
    v_fma_mix_f32 v61, v134, v42, v46 op_sel_hi:[1,0,0]
    v_fma_mix_f32 v62, v138, v42, v46 op_sel_hi:[1,0,0]
    v_fma_mix_f32 v63, v142, v42, v46 op_sel_hi:[1,0,0]
    v_mul_f32 v56, v56, v48
    v_mul_f32 v57, v57, v49
    v_mul_f32 v58, v58, v50
    v_mul_f32 v59, v59, v51
    v_mul_f32 v60, v60, v52
    v_mul_f32 v61, v61, v53
    v_mul_f32 v62, v62, v54
    v_mul_f32 v63, v63, v55
    v_cvt_pk_bf16_f32 v72, v56, v57
    v_cvt_pk_bf16_f32 v73, v58, v59
    v_cvt_pk_bf16_f32 v74, v60, v61
    v_cvt_pk_bf16_f32 v75, v62, v63
    ds_write_b128 v111, v[72:75] offset:0
    v_fma_mix_f32 v56, v115, v43, v47 op_sel_hi:[1,0,0]
    v_fma_mix_f32 v57, v119, v43, v47 op_sel_hi:[1,0,0]
    v_fma_mix_f32 v58, v123, v43, v47 op_sel_hi:[1,0,0]
    v_fma_mix_f32 v59, v127, v43, v47 op_sel_hi:[1,0,0]
    v_fma_mix_f32 v60, v131, v43, v47 op_sel_hi:[1,0,0]
    v_fma_mix_f32 v61, v135, v43, v47 op_sel_hi:[1,0,0]
    v_fma_mix_f32 v62, v139, v43, v47 op_sel_hi:[1,0,0]
    v_fma_mix_f32 v63, v143, v43, v47 op_sel_hi:[1,0,0]
    v_mul_f32 v56, v56, v48
    v_mul_f32 v57, v57, v49
    v_mul_f32 v58, v58, v50
    v_mul_f32 v59, v59, v51
    v_mul_f32 v60, v60, v52
    v_mul_f32 v61, v61, v53
    v_mul_f32 v62, v62, v54
    v_mul_f32 v63, v63, v55
    v_cvt_pk_bf16_f32 v76, v56, v57
    v_cvt_pk_bf16_f32 v77, v58, v59
    v_cvt_pk_bf16_f32 v78, v60, v61
    v_cvt_pk_bf16_f32 v79, v62, v63
    ds_write_b128 v95, v[76:79] offset:0
    s_add_u32 s36, s28, 1
    s_and_b32 s36, s36, 7
    s_lshl_b32 s36, s36, 1
    s_lshl_b32 s45, s36, 7
    s_add_u32 s45, s45, s33
    s_add_u32 m0, s34, 98304
    s_nop 0
    buffer_load_dwordx4 v96, s[4:7], s45 offen offset:0  lds
    buffer_load_dwordx4 v97, s[4:7], s45 offen offset:1024  lds
    buffer_load_dwordx4 v98, s[4:7], s45 offen offset:2048  lds
    buffer_load_dwordx4 v99, s[4:7], s45 offen offset:3072  lds
    s_add_u32 m0, s34, 102400
    s_nop 0
    buffer_load_dwordx4 v100, s[4:7], s45 offen offset:0  lds
    buffer_load_dwordx4 v101, s[4:7], s45 offen offset:1024  lds
    buffer_load_dwordx4 v102, s[4:7], s45 offen offset:2048  lds
    buffer_load_dwordx4 v103, s[4:7], s45 offen offset:3072  lds
    s_mov_b64 exec, 0xff
    buffer_load_dword v107, v105, s[88:91], s100 offen sc1
    s_mov_b64 exec, -1
    s_waitcnt vmcnt(0) lgkmcnt(0)
    v_sub_u32 v108, v107, v106
    s_nop 1
    s_barrier
    s_add_u32 s101, s28, 1
    s_and_b32 s101, s101, 7
    s_mov_b32 s37, 0
L_need2:
    v_readlane_b32 s38, v108, s101
    s_nop 3
    s_cmp_ge_u32 s38, 1
    s_cbranch_scc1 L_nok2
    s_add_u32 s37, s37, 1
    s_cmp_lt_u32 s37, 4000
    s_cbranch_scc0 L_nok2
    s_mov_b64 exec, 0xff
    buffer_load_dword v107, v105, s[88:91], s100 offen sc1
    s_mov_b64 exec, -1
    s_waitcnt vmcnt(0)
    v_sub_u32 v108, v107, v106
    s_nop 1
    s_branch L_need2
L_nok2:
    s_add_u32 s36, s28, 1
    s_and_b32 s36, s36, 7
    s_lshl_b32 s36, s36, 1
    s_lshl_b32 s47, s36, 14
    s_add_u32 s47, s47, s43
    s_lshl_b32 s35, s41, 12
    s_add_u32 m0, s35, 131072
    s_nop 0
    buffer_load_dwordx4 v104, s[88:91], s47 offen offset:0 sc1 lds
    buffer_load_dwordx4 v104, s[88:91], s47 offen offset:1024 sc1 lds
    buffer_load_dwordx4 v104, s[88:91], s47 offen offset:2048 sc1 lds
    buffer_load_dwordx4 v104, s[88:91], s47 offen offset:3072 sc1 lds
    ds_read_b128 v[0:3], v94 offset:0
    ds_read_b128 v[4:7], v94 offset:1024
    ds_read_b128 v[8:11], v94 offset:2048
    ds_read_b128 v[12:15], v94 offset:3072
    s_add_u32 s36, s31, 1
    s_lshl_b32 s36, s36, 14
    s_add_u32 s36, s36, s43
    s_waitcnt lgkmcnt(3)
    buffer_store_dwordx4 v[0:3], v104, s[88:91], s36 offen offset:0 sc1
    s_waitcnt lgkmcnt(2)
    buffer_store_dwordx4 v[4:7], v104, s[88:91], s36 offen offset:1024 sc1
    s_waitcnt lgkmcnt(1)
    buffer_store_dwordx4 v[8:11], v104, s[88:91], s36 offen offset:2048 sc1
    s_waitcnt lgkmcnt(0)
    buffer_store_dwordx4 v[12:15], v104, s[88:91], s36 offen offset:3072 sc1
    s_add_u32 s36, s28, 2
    s_and_b32 s36, s36, 7
    s_lshl_b32 s36, s36, 1
    s_lshl_b32 s45, s36, 7
    s_add_u32 s45, s45, s33
    s_add_u32 m0, s34, 0
    s_nop 0
    buffer_load_dwordx4 v96, s[4:7], s45 offen offset:0  lds
    buffer_load_dwordx4 v97, s[4:7], s45 offen offset:1024  lds
    buffer_load_dwordx4 v98, s[4:7], s45 offen offset:2048  lds
    buffer_load_dwordx4 v99, s[4:7], s45 offen offset:3072  lds
    s_add_u32 m0, s34, 4096
    s_nop 0
    buffer_load_dwordx4 v100, s[4:7], s45 offen offset:0  lds
    buffer_load_dwordx4 v101, s[4:7], s45 offen offset:1024  lds
    buffer_load_dwordx4 v102, s[4:7], s45 offen offset:2048  lds
    buffer_load_dwordx4 v103, s[4:7], s45 offen offset:3072  lds
    s_waitcnt vmcnt(12)
    s_barrier
    s_add_u32 s101, s28, 2
    s_and_b32 s101, s101, 7
    s_mov_b32 s37, 0
L_need3:
    v_readlane_b32 s38, v108, s101
    s_nop 3
    s_cmp_ge_u32 s38, 1
    s_cbranch_scc1 L_nok3
    s_add_u32 s37, s37, 1
    s_cmp_lt_u32 s37, 4000
    s_cbranch_scc0 L_nok3
    s_mov_b64 exec, 0xff
    buffer_load_dword v107, v105, s[88:91], s100 offen sc1
    s_mov_b64 exec, -1
    s_waitcnt vmcnt(0)
    v_sub_u32 v108, v107, v106
    s_nop 1
    s_branch L_need3
L_nok3:
    s_add_u32 s36, s28, 2
    s_and_b32 s36, s36, 7
    s_lshl_b32 s36, s36, 1
    s_lshl_b32 s47, s36, 14
    s_add_u32 s47, s47, s43
    s_lshl_b32 s35, s41, 12
    s_add_u32 m0, s35, 32768
    s_nop 0
    buffer_load_dwordx4 v104, s[88:91], s47 offen offset:0 sc1 lds
    buffer_load_dwordx4 v104, s[88:91], s47 offen offset:1024 sc1 lds
    buffer_load_dwordx4 v104, s[88:91], s47 offen offset:2048 sc1 lds
    buffer_load_dwordx4 v104, s[88:91], s47 offen offset:3072 sc1 lds
    s_add_u32 s101, s28, 3
    s_and_b32 s101, s101, 7
    s_mov_b32 s37, 0
L_need4:
    v_readlane_b32 s38, v108, s101
    s_nop 3
    s_cmp_ge_u32 s38, 1
    s_cbranch_scc1 L_nok4
    s_add_u32 s37, s37, 1
    s_cmp_lt_u32 s37, 4000
    s_cbranch_scc0 L_nok4
    s_mov_b64 exec, 0xff
    buffer_load_dword v107, v105, s[88:91], s100 offen sc1
    s_mov_b64 exec, -1
    s_waitcnt vmcnt(0)
    v_sub_u32 v108, v107, v106
    s_nop 1
    s_branch L_need4
L_nok4:
    s_add_u32 s36, s28, 3
    s_and_b32 s36, s36, 7
    s_lshl_b32 s36, s36, 1
    s_lshl_b32 s47, s36, 14
    s_add_u32 s47, s47, s43
    s_lshl_b32 s35, s41, 12
    s_add_u32 m0, s35, 81920
    s_nop 0
    buffer_load_dwordx4 v104, s[88:91], s47 offen offset:0 sc1 lds
    buffer_load_dwordx4 v104, s[88:91], s47 offen offset:1024 sc1 lds
    buffer_load_dwordx4 v104, s[88:91], s47 offen offset:2048 sc1 lds
    buffer_load_dwordx4 v104, s[88:91], s47 offen offset:3072 sc1 lds
    s_add_u32 s36, s28, 3
    s_and_b32 s36, s36, 7
    s_lshl_b32 s36, s36, 1
    s_lshl_b32 s45, s36, 7
    s_add_u32 s45, s45, s33
    s_add_u32 m0, s34, 49152
    s_nop 0
    buffer_load_dwordx4 v96, s[4:7], s45 offen offset:0  lds
    buffer_load_dwordx4 v97, s[4:7], s45 offen offset:1024  lds
    buffer_load_dwordx4 v98, s[4:7], s45 offen offset:2048  lds
    buffer_load_dwordx4 v99, s[4:7], s45 offen offset:3072  lds
    s_add_u32 m0, s34, 53248
    s_nop 0
    buffer_load_dwordx4 v100, s[4:7], s45 offen offset:0  lds
    buffer_load_dwordx4 v101, s[4:7], s45 offen offset:1024  lds
    buffer_load_dwordx4 v102, s[4:7], s45 offen offset:2048  lds
    buffer_load_dwordx4 v103, s[4:7], s45 offen offset:3072  lds
    s_waitcnt vmcnt(12)
    s_barrier
    s_cmp_eq_u32 s30, 4
    s_cselect_b32 s38, 1, 0
    s_lshl_b32 s37, s28, 7
    s_add_u32 s37, s37, s100
    s_cmp_eq_u32 s38, 1
    s_cselect_b32 s37, s37, 0x7ff00000
    v_readlane_b32 s36, v106, s28
    s_nop 3
    s_add_u32 s36, s36, 2
    v_mov_b32 v91, s36
    v_mov_b32 v92, 0
    s_mov_b64 exec, 1
    buffer_store_dword v91, v92, s[88:91], s37 offen sc1
    s_mov_b64 exec, -1
    s_add_u32 s101, s28, 4
    s_and_b32 s101, s101, 7
    s_mov_b32 s37, 0
L_need5:
    v_readlane_b32 s38, v108, s101
    s_nop 3
    s_cmp_ge_u32 s38, 1
    s_cbranch_scc1 L_nok5
    s_add_u32 s37, s37, 1
    s_cmp_lt_u32 s37, 4000
    s_cbranch_scc0 L_nok5
    s_mov_b64 exec, 0xff
    buffer_load_dword v107, v105, s[88:91], s100 offen sc1
    s_mov_b64 exec, -1
    s_waitcnt vmcnt(0)
    v_sub_u32 v108, v107, v106
    s_nop 1
    s_branch L_need5
L_nok5:
    s_add_u32 s36, s28, 4
    s_and_b32 s36, s36, 7
    s_lshl_b32 s36, s36, 1
    s_lshl_b32 s47, s36, 14
    s_add_u32 s47, s47, s43
    s_lshl_b32 s35, s41, 12
    s_add_u32 m0, s35, 131072
    s_nop 0
    buffer_load_dwordx4 v104, s[88:91], s47 offen offset:0 sc1 lds
    buffer_load_dwordx4 v104, s[88:91], s47 offen offset:1024 sc1 lds
    buffer_load_dwordx4 v104, s[88:91], s47 offen offset:2048 sc1 lds
    buffer_load_dwordx4 v104, s[88:91], s47 offen offset:3072 sc1 lds
    s_add_u32 s36, s28, 4
    s_and_b32 s36, s36, 7
    s_lshl_b32 s36, s36, 1
    s_lshl_b32 s45, s36, 7
    s_add_u32 s45, s45, s33
    s_add_u32 m0, s34, 98304
    s_nop 0
    buffer_load_dwordx4 v96, s[4:7], s45 offen offset:0  lds
    buffer_load_dwordx4 v97, s[4:7], s45 offen offset:1024  lds
    buffer_load_dwordx4 v98, s[4:7], s45 offen offset:2048  lds
    buffer_load_dwordx4 v99, s[4:7], s45 offen offset:3072  lds
    s_add_u32 m0, s34, 102400
    s_nop 0
    buffer_load_dwordx4 v100, s[4:7], s45 offen offset:0  lds
    buffer_load_dwordx4 v101, s[4:7], s45 offen offset:1024  lds
    buffer_load_dwordx4 v102, s[4:7], s45 offen offset:2048  lds
    buffer_load_dwordx4 v103, s[4:7], s45 offen offset:3072  lds
    s_waitcnt vmcnt(13)
    s_barrier
    s_add_u32 s101, s28, 5
    s_and_b32 s101, s101, 7
    s_mov_b32 s37, 0
L_need6:
    v_readlane_b32 s38, v108, s101
    s_nop 3
    s_cmp_ge_u32 s38, 1
    s_cbranch_scc1 L_nok6
    s_add_u32 s37, s37, 1
    s_cmp_lt_u32 s37, 4000
    s_cbranch_scc0 L_nok6
    s_mov_b64 exec, 0xff
    buffer_load_dword v107, v105, s[88:91], s100 offen sc1
    s_mov_b64 exec, -1
    s_waitcnt vmcnt(0)
    v_sub_u32 v108, v107, v106
    s_nop 1
    s_branch L_need6
L_nok6:
    s_add_u32 s36, s28, 5
    s_and_b32 s36, s36, 7
    s_lshl_b32 s36, s36, 1
    s_lshl_b32 s47, s36, 14
    s_add_u32 s47, s47, s43
    s_lshl_b32 s35, s41, 12
    s_add_u32 m0, s35, 32768
    s_nop 0
    buffer_load_dwordx4 v104, s[88:91], s47 offen offset:0 sc1 lds
    buffer_load_dwordx4 v104, s[88:91], s47 offen offset:1024 sc1 lds
    buffer_load_dwordx4 v104, s[88:91], s47 offen offset:2048 sc1 lds
    buffer_load_dwordx4 v104, s[88:91], s47 offen offset:3072 sc1 lds
    s_add_u32 s36, s28, 5
    s_and_b32 s36, s36, 7
    s_lshl_b32 s36, s36, 1
    s_lshl_b32 s45, s36, 7
    s_add_u32 s45, s45, s33
    s_add_u32 m0, s34, 0
    s_nop 0
    buffer_load_dwordx4 v96, s[4:7], s45 offen offset:0  lds
    buffer_load_dwordx4 v97, s[4:7], s45 offen offset:1024  lds
    buffer_load_dwordx4 v98, s[4:7], s45 offen offset:2048  lds
    buffer_load_dwordx4 v99, s[4:7], s45 offen offset:3072  lds
    s_add_u32 m0, s34, 4096
    s_nop 0
    buffer_load_dwordx4 v100, s[4:7], s45 offen offset:0  lds
    buffer_load_dwordx4 v101, s[4:7], s45 offen offset:1024  lds
    buffer_load_dwordx4 v102, s[4:7], s45 offen offset:2048  lds
    buffer_load_dwordx4 v103, s[4:7], s45 offen offset:3072  lds
    s_waitcnt vmcnt(12)
    s_barrier
    s_add_u32 s101, s28, 6
    s_and_b32 s101, s101, 7
    s_mov_b32 s37, 0
L_need7:
    v_readlane_b32 s38, v108, s101
    s_nop 3
    s_cmp_ge_u32 s38, 1
    s_cbranch_scc1 L_nok7
    s_add_u32 s37, s37, 1
    s_cmp_lt_u32 s37, 4000
    s_cbranch_scc0 L_nok7
    s_mov_b64 exec, 0xff
    buffer_load_dword v107, v105, s[88:91], s100 offen sc1
    s_mov_b64 exec, -1
    s_waitcnt vmcnt(0)
    v_sub_u32 v108, v107, v106
    s_nop 1
    s_branch L_need7
L_nok7:
    s_add_u32 s36, s28, 6
    s_and_b32 s36, s36, 7
    s_lshl_b32 s36, s36, 1
    s_lshl_b32 s47, s36, 14
    s_add_u32 s47, s47, s43
    s_lshl_b32 s35, s41, 12
    s_add_u32 m0, s35, 81920
    s_nop 0
    buffer_load_dwordx4 v104, s[88:91], s47 offen offset:0 sc1 lds
    buffer_load_dwordx4 v104, s[88:91], s47 offen offset:1024 sc1 lds
    buffer_load_dwordx4 v104, s[88:91], s47 offen offset:2048 sc1 lds
    buffer_load_dwordx4 v104, s[88:91], s47 offen offset:3072 sc1 lds
    s_add_u32 s36, s28, 6
    s_and_b32 s36, s36, 7
    s_lshl_b32 s36, s36, 1
    s_lshl_b32 s45, s36, 7
    s_add_u32 s45, s45, s33
    s_add_u32 m0, s34, 49152
    s_nop 0
    buffer_load_dwordx4 v96, s[4:7], s45 offen offset:0  lds
    buffer_load_dwordx4 v97, s[4:7], s45 offen offset:1024  lds
    buffer_load_dwordx4 v98, s[4:7], s45 offen offset:2048  lds
    buffer_load_dwordx4 v99, s[4:7], s45 offen offset:3072  lds
    s_add_u32 m0, s34, 53248
    s_nop 0
    buffer_load_dwordx4 v100, s[4:7], s45 offen offset:0  lds
    buffer_load_dwordx4 v101, s[4:7], s45 offen offset:1024  lds
    buffer_load_dwordx4 v102, s[4:7], s45 offen offset:2048  lds
    buffer_load_dwordx4 v103, s[4:7], s45 offen offset:3072  lds
    s_waitcnt vmcnt(12)
    s_barrier
    s_mov_b64 exec, 0xff
    buffer_load_dword v107, v105, s[88:91], s100 offen sc1
    s_mov_b64 exec, -1
    s_add_u32 s101, s28, 7
    s_and_b32 s101, s101, 7
    s_mov_b32 s37, 0
L_need8:
    v_readlane_b32 s38, v108, s101
    s_nop 3
    s_cmp_ge_u32 s38, 1
    s_cbranch_scc1 L_nok8
    s_add_u32 s37, s37, 1
    s_cmp_lt_u32 s37, 4000
    s_cbranch_scc0 L_nok8
    s_mov_b64 exec, 0xff
    buffer_load_dword v107, v105, s[88:91], s100 offen sc1
    s_mov_b64 exec, -1
    s_waitcnt vmcnt(0)
    v_sub_u32 v108, v107, v106
    s_nop 1
    s_branch L_need8
L_nok8:
    s_add_u32 s36, s28, 7
    s_and_b32 s36, s36, 7
    s_lshl_b32 s36, s36, 1
    s_lshl_b32 s47, s36, 14
    s_add_u32 s47, s47, s43
    s_lshl_b32 s35, s41, 12
    s_add_u32 m0, s35, 131072
    s_nop 0
    buffer_load_dwordx4 v104, s[88:91], s47 offen offset:0 sc1 lds
    buffer_load_dwordx4 v104, s[88:91], s47 offen offset:1024 sc1 lds
    buffer_load_dwordx4 v104, s[88:91], s47 offen offset:2048 sc1 lds
    buffer_load_dwordx4 v104, s[88:91], s47 offen offset:3072 sc1 lds
    s_add_u32 s36, s28, 7
    s_and_b32 s36, s36, 7
    s_lshl_b32 s36, s36, 1
    s_lshl_b32 s45, s36, 7
    s_add_u32 s45, s45, s33
    s_add_u32 m0, s34, 98304
    s_nop 0
    buffer_load_dwordx4 v96, s[4:7], s45 offen offset:0  lds
    buffer_load_dwordx4 v97, s[4:7], s45 offen offset:1024  lds
    buffer_load_dwordx4 v98, s[4:7], s45 offen offset:2048  lds
    buffer_load_dwordx4 v99, s[4:7], s45 offen offset:3072  lds
    s_add_u32 m0, s34, 102400
    s_nop 0
    buffer_load_dwordx4 v100, s[4:7], s45 offen offset:0  lds
    buffer_load_dwordx4 v101, s[4:7], s45 offen offset:1024  lds
    buffer_load_dwordx4 v102, s[4:7], s45 offen offset:2048  lds
    buffer_load_dwordx4 v103, s[4:7], s45 offen offset:3072  lds
    s_waitcnt vmcnt(13)
    s_waitcnt vmcnt(12)
    v_sub_u32 v108, v107, v106
    s_nop 1
    s_barrier
    s_add_u32 s101, s28, 1
    s_and_b32 s101, s101, 7
    s_mov_b32 s37, 0
L_need9:
    v_readlane_b32 s38, v108, s101
    s_nop 3
    s_cmp_ge_u32 s38, 2
    s_cbranch_scc1 L_nok9
    s_add_u32 s37, s37, 1
    s_cmp_lt_u32 s37, 4000
    s_cbranch_scc0 L_nok9
    s_mov_b64 exec, 0xff
    buffer_load_dword v107, v105, s[88:91], s100 offen sc1
    s_mov_b64 exec, -1
    s_waitcnt vmcnt(0)
    v_sub_u32 v108, v107, v106
    s_nop 1
    s_branch L_need9
L_nok9:
    s_add_u32 s36, s28, 1
    s_and_b32 s36, s36, 7
    s_lshl_b32 s36, s36, 1
    s_add_u32 s36, s36, 1
    s_lshl_b32 s47, s36, 14
    s_add_u32 s47, s47, s43
    s_lshl_b32 s35, s41, 12
    s_add_u32 m0, s35, 32768
    s_nop 0
    buffer_load_dwordx4 v104, s[88:91], s47 offen offset:0 sc1 lds
    buffer_load_dwordx4 v104, s[88:91], s47 offen offset:1024 sc1 lds
    buffer_load_dwordx4 v104, s[88:91], s47 offen offset:2048 sc1 lds
    buffer_load_dwordx4 v104, s[88:91], s47 offen offset:3072 sc1 lds
    s_add_u32 s36, s28, 1
    s_and_b32 s36, s36, 7
    s_lshl_b32 s36, s36, 1
    s_add_u32 s36, s36, 1
    s_lshl_b32 s45, s36, 7
    s_add_u32 s45, s45, s33
    s_add_u32 m0, s34, 0
    s_nop 0
    buffer_load_dwordx4 v96, s[4:7], s45 offen offset:0  lds
    buffer_load_dwordx4 v97, s[4:7], s45 offen offset:1024  lds
    buffer_load_dwordx4 v98, s[4:7], s45 offen offset:2048  lds
    buffer_load_dwordx4 v99, s[4:7], s45 offen offset:3072  lds
    s_add_u32 m0, s34, 4096
    s_nop 0
    buffer_load_dwordx4 v100, s[4:7], s45 offen offset:0  lds
    buffer_load_dwordx4 v101, s[4:7], s45 offen offset:1024  lds
    buffer_load_dwordx4 v102, s[4:7], s45 offen offset:2048  lds
    buffer_load_dwordx4 v103, s[4:7], s45 offen offset:3072  lds
    s_waitcnt vmcnt(12)
    s_barrier
    s_add_u32 s101, s28, 2
    s_and_b32 s101, s101, 7
    s_mov_b32 s37, 0
L_need10:
    v_readlane_b32 s38, v108, s101
    s_nop 3
    s_cmp_ge_u32 s38, 2
    s_cbranch_scc1 L_nok10
    s_add_u32 s37, s37, 1
    s_cmp_lt_u32 s37, 4000
    s_cbranch_scc0 L_nok10
    s_mov_b64 exec, 0xff
    buffer_load_dword v107, v105, s[88:91], s100 offen sc1
    s_mov_b64 exec, -1
    s_waitcnt vmcnt(0)
    v_sub_u32 v108, v107, v106
    s_nop 1
    s_branch L_need10
L_nok10:
    s_add_u32 s36, s28, 2
    s_and_b32 s36, s36, 7
    s_lshl_b32 s36, s36, 1
    s_add_u32 s36, s36, 1
    s_lshl_b32 s47, s36, 14
    s_add_u32 s47, s47, s43
    s_lshl_b32 s35, s41, 12
    s_add_u32 m0, s35, 81920
    s_nop 0
    buffer_load_dwordx4 v104, s[88:91], s47 offen offset:0 sc1 lds
    buffer_load_dwordx4 v104, s[88:91], s47 offen offset:1024 sc1 lds
    buffer_load_dwordx4 v104, s[88:91], s47 offen offset:2048 sc1 lds
    buffer_load_dwordx4 v104, s[88:91], s47 offen offset:3072 sc1 lds
    s_add_u32 s36, s28, 2
    s_and_b32 s36, s36, 7
    s_lshl_b32 s36, s36, 1
    s_add_u32 s36, s36, 1
    s_lshl_b32 s45, s36, 7
    s_add_u32 s45, s45, s33
    s_add_u32 m0, s34, 49152
    s_nop 0
    buffer_load_dwordx4 v96, s[4:7], s45 offen offset:0  lds
    buffer_load_dwordx4 v97, s[4:7], s45 offen offset:1024  lds
    buffer_load_dwordx4 v98, s[4:7], s45 offen offset:2048  lds
    buffer_load_dwordx4 v99, s[4:7], s45 offen offset:3072  lds
    s_add_u32 m0, s34, 53248
    s_nop 0
    buffer_load_dwordx4 v100, s[4:7], s45 offen offset:0  lds
    buffer_load_dwordx4 v101, s[4:7], s45 offen offset:1024  lds
    buffer_load_dwordx4 v102, s[4:7], s45 offen offset:2048  lds
    buffer_load_dwordx4 v103, s[4:7], s45 offen offset:3072  lds
    s_waitcnt vmcnt(12)
    s_barrier
    s_add_u32 s101, s28, 3
    s_and_b32 s101, s101, 7
    s_mov_b32 s37, 0
L_need11:
    v_readlane_b32 s38, v108, s101
    s_nop 3
    s_cmp_ge_u32 s38, 2
    s_cbranch_scc1 L_nok11
    s_add_u32 s37, s37, 1
    s_cmp_lt_u32 s37, 4000
    s_cbranch_scc0 L_nok11
    s_mov_b64 exec, 0xff
    buffer_load_dword v107, v105, s[88:91], s100 offen sc1
    s_mov_b64 exec, -1
    s_waitcnt vmcnt(0)
    v_sub_u32 v108, v107, v106
    s_nop 1
    s_branch L_need11
L_nok11:
    s_add_u32 s36, s28, 3
    s_and_b32 s36, s36, 7
    s_lshl_b32 s36, s36, 1
    s_add_u32 s36, s36, 1
    s_lshl_b32 s47, s36, 14
    s_add_u32 s47, s47, s43
    s_lshl_b32 s35, s41, 12
    s_add_u32 m0, s35, 131072
    s_nop 0
    buffer_load_dwordx4 v104, s[88:91], s47 offen offset:0 sc1 lds
    buffer_load_dwordx4 v104, s[88:91], s47 offen offset:1024 sc1 lds
    buffer_load_dwordx4 v104, s[88:91], s47 offen offset:2048 sc1 lds
    buffer_load_dwordx4 v104, s[88:91], s47 offen offset:3072 sc1 lds
    s_add_u32 s36, s28, 3
    s_and_b32 s36, s36, 7
    s_lshl_b32 s36, s36, 1
    s_add_u32 s36, s36, 1
    s_lshl_b32 s45, s36, 7
    s_add_u32 s45, s45, s33
    s_add_u32 m0, s34, 98304
    s_nop 0
    buffer_load_dwordx4 v96, s[4:7], s45 offen offset:0  lds
    buffer_load_dwordx4 v97, s[4:7], s45 offen offset:1024  lds
    buffer_load_dwordx4 v98, s[4:7], s45 offen offset:2048  lds
    buffer_load_dwordx4 v99, s[4:7], s45 offen offset:3072  lds
    s_add_u32 m0, s34, 102400
    s_nop 0
    buffer_load_dwordx4 v100, s[4:7], s45 offen offset:0  lds
    buffer_load_dwordx4 v101, s[4:7], s45 offen offset:1024  lds
    buffer_load_dwordx4 v102, s[4:7], s45 offen offset:2048  lds
    buffer_load_dwordx4 v103, s[4:7], s45 offen offset:3072  lds
    s_waitcnt vmcnt(12)
    s_barrier
    s_add_u32 s101, s28, 4
    s_and_b32 s101, s101, 7
    s_mov_b32 s37, 0
L_need12:
    v_readlane_b32 s38, v108, s101
    s_nop 3
    s_cmp_ge_u32 s38, 2
    s_cbranch_scc1 L_nok12
    s_add_u32 s37, s37, 1
    s_cmp_lt_u32 s37, 4000
    s_cbranch_scc0 L_nok12
    s_mov_b64 exec, 0xff
    buffer_load_dword v107, v105, s[88:91], s100 offen sc1
    s_mov_b64 exec, -1
    s_waitcnt vmcnt(0)
    v_sub_u32 v108, v107, v106
    s_nop 1
    s_branch L_need12
L_nok12:
    s_add_u32 s36, s28, 4
    s_and_b32 s36, s36, 7
    s_lshl_b32 s36, s36, 1
    s_add_u32 s36, s36, 1
    s_lshl_b32 s47, s36, 14
    s_add_u32 s47, s47, s43
    s_lshl_b32 s35, s41, 12
    s_add_u32 m0, s35, 32768
    s_nop 0
    buffer_load_dwordx4 v104, s[88:91], s47 offen offset:0 sc1 lds
    buffer_load_dwordx4 v104, s[88:91], s47 offen offset:1024 sc1 lds
    buffer_load_dwordx4 v104, s[88:91], s47 offen offset:2048 sc1 lds
    buffer_load_dwordx4 v104, s[88:91], s47 offen offset:3072 sc1 lds
    s_add_u32 s36, s28, 4
    s_and_b32 s36, s36, 7
    s_lshl_b32 s36, s36, 1
    s_add_u32 s36, s36, 1
    s_lshl_b32 s45, s36, 7
    s_add_u32 s45, s45, s33
    s_add_u32 m0, s34, 0
    s_nop 0
    buffer_load_dwordx4 v96, s[4:7], s45 offen offset:0  lds
    buffer_load_dwordx4 v97, s[4:7], s45 offen offset:1024  lds
    buffer_load_dwordx4 v98, s[4:7], s45 offen offset:2048  lds
    buffer_load_dwordx4 v99, s[4:7], s45 offen offset:3072  lds
    s_add_u32 m0, s34, 4096
    s_nop 0
    buffer_load_dwordx4 v100, s[4:7], s45 offen offset:0  lds
    buffer_load_dwordx4 v101, s[4:7], s45 offen offset:1024  lds
    buffer_load_dwordx4 v102, s[4:7], s45 offen offset:2048  lds
    buffer_load_dwordx4 v103, s[4:7], s45 offen offset:3072  lds
    s_waitcnt vmcnt(12)
    s_barrier
    s_add_u32 s101, s28, 5
    s_and_b32 s101, s101, 7
    s_mov_b32 s37, 0
L_need13:
    v_readlane_b32 s38, v108, s101
    s_nop 3
    s_cmp_ge_u32 s38, 2
    s_cbranch_scc1 L_nok13
    s_add_u32 s37, s37, 1
    s_cmp_lt_u32 s37, 4000
    s_cbranch_scc0 L_nok13
    s_mov_b64 exec, 0xff
    buffer_load_dword v107, v105, s[88:91], s100 offen sc1
    s_mov_b64 exec, -1
    s_waitcnt vmcnt(0)
    v_sub_u32 v108, v107, v106
    s_nop 1
    s_branch L_need13
L_nok13:
    s_add_u32 s36, s28, 5
    s_and_b32 s36, s36, 7
    s_lshl_b32 s36, s36, 1
    s_add_u32 s36, s36, 1
    s_lshl_b32 s47, s36, 14
    s_add_u32 s47, s47, s43
    s_lshl_b32 s35, s41, 12
    s_add_u32 m0, s35, 81920
    s_nop 0
    buffer_load_dwordx4 v104, s[88:91], s47 offen offset:0 sc1 lds
    buffer_load_dwordx4 v104, s[88:91], s47 offen offset:1024 sc1 lds
    buffer_load_dwordx4 v104, s[88:91], s47 offen offset:2048 sc1 lds
    buffer_load_dwordx4 v104, s[88:91], s47 offen offset:3072 sc1 lds
    s_add_u32 s36, s28, 5
    s_and_b32 s36, s36, 7
    s_lshl_b32 s36, s36, 1
    s_add_u32 s36, s36, 1
    s_lshl_b32 s45, s36, 7
    s_add_u32 s45, s45, s33
    s_add_u32 m0, s34, 49152
    s_nop 0
    buffer_load_dwordx4 v96, s[4:7], s45 offen offset:0  lds
    buffer_load_dwordx4 v97, s[4:7], s45 offen offset:1024  lds
    buffer_load_dwordx4 v98, s[4:7], s45 offen offset:2048  lds
    buffer_load_dwordx4 v99, s[4:7], s45 offen offset:3072  lds
    s_add_u32 m0, s34, 53248
    s_nop 0
    buffer_load_dwordx4 v100, s[4:7], s45 offen offset:0  lds
    buffer_load_dwordx4 v101, s[4:7], s45 offen offset:1024  lds
    buffer_load_dwordx4 v102, s[4:7], s45 offen offset:2048  lds
    buffer_load_dwordx4 v103, s[4:7], s45 offen offset:3072  lds
    s_waitcnt vmcnt(12)
    s_barrier
    s_add_u32 s101, s28, 6
    s_and_b32 s101, s101, 7
    s_mov_b32 s37, 0
L_need14:
    v_readlane_b32 s38, v108, s101
    s_nop 3
    s_cmp_ge_u32 s38, 2
    s_cbranch_scc1 L_nok14
    s_add_u32 s37, s37, 1
    s_cmp_lt_u32 s37, 4000
    s_cbranch_scc0 L_nok14
    s_mov_b64 exec, 0xff
    buffer_load_dword v107, v105, s[88:91], s100 offen sc1
    s_mov_b64 exec, -1
    s_waitcnt vmcnt(0)
    v_sub_u32 v108, v107, v106
    s_nop 1
    s_branch L_need14
L_nok14:
    s_add_u32 s36, s28, 6
    s_and_b32 s36, s36, 7
    s_lshl_b32 s36, s36, 1
    s_add_u32 s36, s36, 1
    s_lshl_b32 s47, s36, 14
    s_add_u32 s47, s47, s43
    s_lshl_b32 s35, s41, 12
    s_add_u32 m0, s35, 131072
    s_nop 0
    buffer_load_dwordx4 v104, s[88:91], s47 offen offset:0 sc1 lds
    buffer_load_dwordx4 v104, s[88:91], s47 offen offset:1024 sc1 lds
    buffer_load_dwordx4 v104, s[88:91], s47 offen offset:2048 sc1 lds
    buffer_load_dwordx4 v104, s[88:91], s47 offen offset:3072 sc1 lds
    s_add_u32 s36, s28, 6
    s_and_b32 s36, s36, 7
    s_lshl_b32 s36, s36, 1
    s_add_u32 s36, s36, 1
    s_lshl_b32 s45, s36, 7
    s_add_u32 s45, s45, s33
    s_add_u32 m0, s34, 98304
    s_nop 0
    buffer_load_dwordx4 v96, s[4:7], s45 offen offset:0  lds
    buffer_load_dwordx4 v97, s[4:7], s45 offen offset:1024  lds
    buffer_load_dwordx4 v98, s[4:7], s45 offen offset:2048  lds
    buffer_load_dwordx4 v99, s[4:7], s45 offen offset:3072  lds
    s_add_u32 m0, s34, 102400
    s_nop 0
    buffer_load_dwordx4 v100, s[4:7], s45 offen offset:0  lds
    buffer_load_dwordx4 v101, s[4:7], s45 offen offset:1024  lds
    buffer_load_dwordx4 v102, s[4:7], s45 offen offset:2048  lds
    buffer_load_dwordx4 v103, s[4:7], s45 offen offset:3072  lds
    s_waitcnt vmcnt(12)
    s_barrier
    s_add_u32 s101, s28, 7
    s_and_b32 s101, s101, 7
    s_mov_b32 s37, 0
L_need15:
    v_readlane_b32 s38, v108, s101
    s_nop 3
    s_cmp_ge_u32 s38, 2
    s_cbranch_scc1 L_nok15
    s_add_u32 s37, s37, 1
    s_cmp_lt_u32 s37, 4000
    s_cbranch_scc0 L_nok15
    s_mov_b64 exec, 0xff
    buffer_load_dword v107, v105, s[88:91], s100 offen sc1
    s_mov_b64 exec, -1
    s_waitcnt vmcnt(0)
    v_sub_u32 v108, v107, v106
    s_nop 1
    s_branch L_need15
L_nok15:
    s_add_u32 s36, s28, 7
    s_and_b32 s36, s36, 7
    s_lshl_b32 s36, s36, 1
    s_add_u32 s36, s36, 1
    s_lshl_b32 s47, s36, 14
    s_add_u32 s47, s47, s43
    s_lshl_b32 s35, s41, 12
    s_add_u32 m0, s35, 32768
    s_nop 0
    buffer_load_dwordx4 v104, s[88:91], s47 offen offset:0 sc1 lds
    buffer_load_dwordx4 v104, s[88:91], s47 offen offset:1024 sc1 lds
    buffer_load_dwordx4 v104, s[88:91], s47 offen offset:2048 sc1 lds
    buffer_load_dwordx4 v104, s[88:91], s47 offen offset:3072 sc1 lds
    s_add_u32 s36, s28, 7
    s_and_b32 s36, s36, 7
    s_lshl_b32 s36, s36, 1
    s_add_u32 s36, s36, 1
    s_lshl_b32 s45, s36, 7
    s_add_u32 s45, s45, s33
    s_add_u32 m0, s34, 0
    s_nop 0
    buffer_load_dwordx4 v96, s[4:7], s45 offen offset:0  lds
    buffer_load_dwordx4 v97, s[4:7], s45 offen offset:1024  lds
    buffer_load_dwordx4 v98, s[4:7], s45 offen offset:2048  lds
    buffer_load_dwordx4 v99, s[4:7], s45 offen offset:3072  lds
    s_add_u32 m0, s34, 4096
    s_nop 0
    buffer_load_dwordx4 v100, s[4:7], s45 offen offset:0  lds
    buffer_load_dwordx4 v101, s[4:7], s45 offen offset:1024  lds
    buffer_load_dwordx4 v102, s[4:7], s45 offen offset:2048  lds
    buffer_load_dwordx4 v103, s[4:7], s45 offen offset:3072  lds
    s_waitcnt vmcnt(12)
    s_barrier
    s_waitcnt vmcnt(0)
    s_barrier
L_end:
    s_endpgm
L_helper:
    s_load_dwordx2 s[68:69], s[0:1], 0
    v_lshrrev_b32 v1, 6, v0
    v_and_b32 v0, 63, v0
    v_readfirstlane_b32 s30, v1
    s_sub_u32 s35, s2, 224
    s_and_b32 s28, s35, 7
    s_lshr_b32 s37, s35, 3
    s_lshl_b32 s36, s28, 8
    s_lshl_b32 s37, s37, 6
    s_add_u32 s36, s36, s37
    s_lshl_b32 s38, s30, 3
    s_add_u32 s36, s36, s38
    s_lshl_b32 s42, s36, 11
    s_lshl_b32 s31, s28, 1
    v_lshrrev_b32 v3, 3, v0
    v_and_b32 v4, 7, v0
    v_lshlrev_b32 v4, 4, v4
    v_lshl_add_u32 v3, v3, 11, v4
    s_waitcnt lgkmcnt(0)
    s_mov_b32 s4, s68
    s_and_b32 s5, s69, 0xffff
    s_mov_b32 s6, 4194304
    s_mov_b32 s7, 0x20000
    s_sub_u32 s39, s2, 224
    s_lshr_b32 s39, s39, 3
    s_add_u32 s35, s31, 0
    s_lshl_b32 s35, s35, 7
    s_add_u32 s35, s35, s42
    buffer_load_dwordx4 v[8:11], v3, s[4:7], s35 offen
    s_waitcnt vmcnt(0)
    s_add_u32 s35, s31, 1
    s_lshl_b32 s35, s35, 7
    s_add_u32 s35, s35, s42
    buffer_load_dwordx4 v[8:11], v3, s[4:7], s35 offen
    s_waitcnt vmcnt(0)
    s_add_u32 s35, s28, 1
    s_and_b32 s35, s35, 7
    s_lshl_b32 s35, s35, 1
    s_lshl_b32 s35, s35, 7
    s_add_u32 s35, s35, s42
    buffer_load_dwordx4 v[8:11], v3, s[4:7], s35 offen
    s_waitcnt vmcnt(0)
    s_add_u32 s35, s28, 2
    s_and_b32 s35, s35, 7
    s_lshl_b32 s35, s35, 1
    s_lshl_b32 s35, s35, 7
    s_add_u32 s35, s35, s42
    buffer_load_dwordx4 v[8:11], v3, s[4:7], s35 offen
    s_waitcnt vmcnt(0)
    s_add_u32 s35, s28, 3
    s_and_b32 s35, s35, 7
    s_lshl_b32 s35, s35, 1
    s_lshl_b32 s35, s35, 7
    s_add_u32 s35, s35, s42
    buffer_load_dwordx4 v[8:11], v3, s[4:7], s35 offen
    s_waitcnt vmcnt(0)
    s_add_u32 s35, s28, 4
    s_and_b32 s35, s35, 7
    s_lshl_b32 s35, s35, 1
    s_lshl_b32 s35, s35, 7
    s_add_u32 s35, s35, s42
    buffer_load_dwordx4 v[8:11], v3, s[4:7], s35 offen
    s_waitcnt vmcnt(0)
    s_add_u32 s35, s28, 5
    s_and_b32 s35, s35, 7
    s_lshl_b32 s35, s35, 1
    s_lshl_b32 s35, s35, 7
    s_add_u32 s35, s35, s42
    buffer_load_dwordx4 v[8:11], v3, s[4:7], s35 offen
    s_waitcnt vmcnt(0)
    s_add_u32 s35, s28, 6
    s_and_b32 s35, s35, 7
    s_lshl_b32 s35, s35, 1
    s_lshl_b32 s35, s35, 7
    s_add_u32 s35, s35, s42
    buffer_load_dwordx4 v[8:11], v3, s[4:7], s35 offen
    s_waitcnt vmcnt(0)
    s_add_u32 s35, s28, 7
    s_and_b32 s35, s35, 7
    s_lshl_b32 s35, s35, 1
    s_lshl_b32 s35, s35, 7
    s_add_u32 s35, s35, s42
    buffer_load_dwordx4 v[8:11], v3, s[4:7], s35 offen
    s_waitcnt vmcnt(0)
    s_add_u32 s35, s28, 1
    s_and_b32 s35, s35, 7
    s_lshl_b32 s35, s35, 1
    s_add_u32 s35, s35, 1
    s_lshl_b32 s35, s35, 7
    s_add_u32 s35, s35, s42
    buffer_load_dwordx4 v[8:11], v3, s[4:7], s35 offen
    s_waitcnt vmcnt(0)
    s_add_u32 s35, s28, 2
    s_and_b32 s35, s35, 7
    s_lshl_b32 s35, s35, 1
    s_add_u32 s35, s35, 1
    s_lshl_b32 s35, s35, 7
    s_add_u32 s35, s35, s42
    buffer_load_dwordx4 v[8:11], v3, s[4:7], s35 offen
    s_waitcnt vmcnt(0)
    s_add_u32 s35, s28, 3
    s_and_b32 s35, s35, 7
    s_lshl_b32 s35, s35, 1
    s_add_u32 s35, s35, 1
    s_lshl_b32 s35, s35, 7
    s_add_u32 s35, s35, s42
    buffer_load_dwordx4 v[8:11], v3, s[4:7], s35 offen
    s_waitcnt vmcnt(0)
    s_add_u32 s35, s28, 4
    s_and_b32 s35, s35, 7
    s_lshl_b32 s35, s35, 1
    s_add_u32 s35, s35, 1
    s_lshl_b32 s35, s35, 7
    s_add_u32 s35, s35, s42
    buffer_load_dwordx4 v[8:11], v3, s[4:7], s35 offen
    s_waitcnt vmcnt(0)
    s_add_u32 s35, s28, 5
    s_and_b32 s35, s35, 7
    s_lshl_b32 s35, s35, 1
    s_add_u32 s35, s35, 1
    s_lshl_b32 s35, s35, 7
    s_add_u32 s35, s35, s42
    buffer_load_dwordx4 v[8:11], v3, s[4:7], s35 offen
    s_waitcnt vmcnt(0)
    s_add_u32 s35, s28, 6
    s_and_b32 s35, s35, 7
    s_lshl_b32 s35, s35, 1
    s_add_u32 s35, s35, 1
    s_lshl_b32 s35, s35, 7
    s_add_u32 s35, s35, s42
    buffer_load_dwordx4 v[8:11], v3, s[4:7], s35 offen
    s_waitcnt vmcnt(0)
    s_add_u32 s35, s28, 7
    s_and_b32 s35, s35, 7
    s_lshl_b32 s35, s35, 1
    s_add_u32 s35, s35, 1
    s_lshl_b32 s35, s35, 7
    s_add_u32 s35, s35, s42
    buffer_load_dwordx4 v[8:11], v3, s[4:7], s35 offen
    s_waitcnt vmcnt(0)
    s_endpgm
L_consumer:
    v_mov_b32 v233, 147456
    v_mov_b32 v234, 0
    ds_write_b32 v233, v234
    v_and_b32 v238, 15, v254
    v_lshrrev_b32 v239, 4, v254
    v_bfe_u32 v240, v254, 1, 3
    v_xor_b32 v241, v239, v240
    v_lshlrev_b32 v241, 4, v241
    v_lshl_add_u32 v229, v238, 7, v241
    s_lshl_b32 s35, s30, 13
    v_add_u32 v225, s35, v229
    v_xor_b32 v226, 64, v225
    v_add_u32 v229, 32768, v229
    v_xor_b32 v230, 16, v229
    v_xor_b32 v231, 64, v229
    v_xor_b32 v232, 0x50, v229
    s_waitcnt lgkmcnt(0)
    s_mov_b32 s24, s78
    s_and_b32 s25, s79, 0xffff
    s_mov_b32 s26, 14680064
    s_mov_b32 s27, 0x20000
    s_lshl_b32 s35, s30, 14
    s_add_u32 s35, s35, 49152
    v_and_b32 v233, 15, v254
    v_lshrrev_b32 v234, 4, v254
    v_and_b32 v235, 7, v254
    v_xor_b32 v235, v235, v234
    v_lshlrev_b32 v235, 4, v235
    v_lshl_add_u32 v236, v233, 8, v235
    v_add_u32 v236, s35, v236
    v_xor_b32 v237, 64, v236
    v_lshrrev_b32 v240, 4, v254
    v_and_b32 v241, 15, v254
    v_xor_b32 v242, v241, v240
    v_lshlrev_b32 v242, 4, v242
    v_lshl_add_u32 v242, v240, 8, v242
    v_add_u32 v242, s35, v242
    v_xor_b32 v243, 64, v242
    s_mov_b32 s36, 7168
    v_mul_lo_u32 v244, s36, v240
    v_lshl_add_u32 v244, v241, 4, v244
    s_lshl_b32 s35, s28, 8
    s_lshl_b32 s36, s30, 6
    s_add_u32 s35, s35, s36
    s_mul_i32 s35, s35, 7168
    s_lshl_b32 s36, s29, 8
    s_add_u32 s42, s35, s36
    v_mov_b32 v0, 0
    v_mov_b32 v1, 0
    v_mov_b32 v2, 0
    v_mov_b32 v3, 0
    v_mov_b32 v4, 0
    v_mov_b32 v5, 0
    v_mov_b32 v6, 0
    v_mov_b32 v7, 0
    v_mov_b32 v8, 0
    v_mov_b32 v9, 0
    v_mov_b32 v10, 0
    v_mov_b32 v11, 0
    v_mov_b32 v12, 0
    v_mov_b32 v13, 0
    v_mov_b32 v14, 0
    v_mov_b32 v15, 0
    v_mov_b32 v16, 0
    v_mov_b32 v17, 0
    v_mov_b32 v18, 0
    v_mov_b32 v19, 0
    v_mov_b32 v20, 0
    v_mov_b32 v21, 0
    v_mov_b32 v22, 0
    v_mov_b32 v23, 0
    v_mov_b32 v24, 0
    v_mov_b32 v25, 0
    v_mov_b32 v26, 0
    v_mov_b32 v27, 0
    v_mov_b32 v28, 0
    v_mov_b32 v29, 0
    v_mov_b32 v30, 0
    v_mov_b32 v31, 0
    v_mov_b32 v32, 0
    v_mov_b32 v33, 0
    v_mov_b32 v34, 0
    v_mov_b32 v35, 0
    v_mov_b32 v36, 0
    v_mov_b32 v37, 0
    v_mov_b32 v38, 0
    v_mov_b32 v39, 0
    v_mov_b32 v40, 0
    v_mov_b32 v41, 0
    v_mov_b32 v42, 0
    v_mov_b32 v43, 0
    v_mov_b32 v44, 0
    v_mov_b32 v45, 0
    v_mov_b32 v46, 0
    v_mov_b32 v47, 0
    v_mov_b32 v48, 0
    v_mov_b32 v49, 0
    v_mov_b32 v50, 0
    v_mov_b32 v51, 0
    v_mov_b32 v52, 0
    v_mov_b32 v53, 0
    v_mov_b32 v54, 0
    v_mov_b32 v55, 0
    v_mov_b32 v56, 0
    v_mov_b32 v57, 0
    v_mov_b32 v58, 0
    v_mov_b32 v59, 0
    v_mov_b32 v60, 0
    v_mov_b32 v61, 0
    v_mov_b32 v62, 0
    v_mov_b32 v63, 0
    v_mov_b32 v64, 0
    v_mov_b32 v65, 0
    v_mov_b32 v66, 0
    v_mov_b32 v67, 0
    v_mov_b32 v68, 0
    v_mov_b32 v69, 0
    v_mov_b32 v70, 0
    v_mov_b32 v71, 0
    v_mov_b32 v72, 0
    v_mov_b32 v73, 0
    v_mov_b32 v74, 0
    v_mov_b32 v75, 0
    v_mov_b32 v76, 0
    v_mov_b32 v77, 0
    v_mov_b32 v78, 0
    v_mov_b32 v79, 0
    v_mov_b32 v80, 0
    v_mov_b32 v81, 0
    v_mov_b32 v82, 0
    v_mov_b32 v83, 0
    v_mov_b32 v84, 0
    v_mov_b32 v85, 0
    v_mov_b32 v86, 0
    v_mov_b32 v87, 0
    v_mov_b32 v88, 0
    v_mov_b32 v89, 0
    v_mov_b32 v90, 0
    v_mov_b32 v91, 0
    v_mov_b32 v92, 0
    v_mov_b32 v93, 0
    v_mov_b32 v94, 0
    v_mov_b32 v95, 0
    v_mov_b32 v96, 0
    v_mov_b32 v97, 0
    v_mov_b32 v98, 0
    v_mov_b32 v99, 0
    v_mov_b32 v100, 0
    v_mov_b32 v101, 0
    v_mov_b32 v102, 0
    v_mov_b32 v103, 0
    v_mov_b32 v104, 0
    v_mov_b32 v105, 0
    v_mov_b32 v106, 0
    v_mov_b32 v107, 0
    v_mov_b32 v108, 0
    v_mov_b32 v109, 0
    v_mov_b32 v110, 0
    v_mov_b32 v111, 0
    v_mov_b32 v112, 0
    v_mov_b32 v113, 0
    v_mov_b32 v114, 0
    v_mov_b32 v115, 0
    v_mov_b32 v116, 0
    v_mov_b32 v117, 0
    v_mov_b32 v118, 0
    v_mov_b32 v119, 0
    v_mov_b32 v120, 0
    v_mov_b32 v121, 0
    v_mov_b32 v122, 0
    v_mov_b32 v123, 0
    v_mov_b32 v124, 0
    v_mov_b32 v125, 0
    v_mov_b32 v126, 0
    v_mov_b32 v127, 0
    v_mov_b32 v144, 0
    v_mov_b32 v145, 0
    v_mov_b32 v146, 0
    v_mov_b32 v147, 0
    v_mov_b32 v148, 0
    v_mov_b32 v149, 0
    v_mov_b32 v150, 0
    v_mov_b32 v151, 0
    v_mov_b32 v152, 0
    v_mov_b32 v153, 0
    v_mov_b32 v154, 0
    v_mov_b32 v155, 0
    v_mov_b32 v156, 0
    v_mov_b32 v157, 0
    v_mov_b32 v158, 0
    v_mov_b32 v159, 0
    v_mov_b32 v192, 0
    v_mov_b32 v193, 0
    v_mov_b32 v194, 0
    v_mov_b32 v195, 0
    v_mov_b32 v196, 0
    v_mov_b32 v197, 0
    v_mov_b32 v198, 0
    v_mov_b32 v199, 0
    v_mov_b32 v200, 0
    v_mov_b32 v201, 0
    v_mov_b32 v202, 0
    v_mov_b32 v203, 0
    v_mov_b32 v204, 0
    v_mov_b32 v205, 0
    v_mov_b32 v206, 0
    v_mov_b32 v207, 0
    v_mov_b32 v208, 0
    v_mov_b32 v209, 0
    v_mov_b32 v210, 0
    v_mov_b32 v211, 0
    v_mov_b32 v212, 0
    v_mov_b32 v213, 0
    v_mov_b32 v214, 0
    v_mov_b32 v215, 0
    v_mov_b32 v216, 0
    v_mov_b32 v217, 0
    v_mov_b32 v218, 0
    v_mov_b32 v219, 0
    v_mov_b32 v220, 0
    v_mov_b32 v221, 0
    v_mov_b32 v222, 0
    v_mov_b32 v223, 0
    s_mov_b32 s32, 0
    s_mov_b32 s44, 49152
    s_mov_b32 s45, 4294868992
    s_mov_b32 s46, 0
L_cloop:
    s_barrier
    v_mfma_f32_16x16x32_bf16 v[0:3], v[192:195], v[144:147], v[0:3]
    ds_read_b128 v[160:163], v229 offset:0
    v_mfma_f32_16x16x32_bf16 v[32:35], v[192:195], v[148:151], v[32:35]
    v_mfma_f32_16x16x32_bf16 v[64:67], v[192:195], v[152:155], v[64:67]
    ds_read_b128 v[128:131], v225 offset:0
    v_mfma_f32_16x16x32_bf16 v[96:99], v[192:195], v[156:159], v[96:99]
    v_mfma_f32_16x16x32_bf16 v[4:7], v[196:199], v[144:147], v[4:7]
    ds_read_b128 v[164:167], v230 offset:2048
    v_mfma_f32_16x16x32_bf16 v[36:39], v[196:199], v[148:151], v[36:39]
    v_mfma_f32_16x16x32_bf16 v[68:71], v[196:199], v[152:155], v[68:71]
    ds_read_b128 v[132:135], v225 offset:2048
    v_mfma_f32_16x16x32_bf16 v[100:103], v[196:199], v[156:159], v[100:103]
    v_mfma_f32_16x16x32_bf16 v[8:11], v[200:203], v[144:147], v[8:11]
    ds_read_b128 v[168:171], v229 offset:4096
    v_mfma_f32_16x16x32_bf16 v[40:43], v[200:203], v[148:151], v[40:43]
    v_mfma_f32_16x16x32_bf16 v[72:75], v[200:203], v[152:155], v[72:75]
    ds_read_b128 v[136:139], v225 offset:4096
    v_mfma_f32_16x16x32_bf16 v[104:107], v[200:203], v[156:159], v[104:107]
    v_mfma_f32_16x16x32_bf16 v[12:15], v[204:207], v[144:147], v[12:15]
    ds_read_b128 v[172:175], v230 offset:6144
    v_mfma_f32_16x16x32_bf16 v[44:47], v[204:207], v[148:151], v[44:47]
    v_mfma_f32_16x16x32_bf16 v[76:79], v[204:207], v[152:155], v[76:79]
    ds_read_b128 v[140:143], v225 offset:6144
    v_mfma_f32_16x16x32_bf16 v[108:111], v[204:207], v[156:159], v[108:111]
    v_mfma_f32_16x16x32_bf16 v[16:19], v[208:211], v[144:147], v[16:19]
    ds_read_b128 v[176:179], v229 offset:8192
    v_mfma_f32_16x16x32_bf16 v[48:51], v[208:211], v[148:151], v[48:51]
    v_mfma_f32_16x16x32_bf16 v[80:83], v[208:211], v[152:155], v[80:83]
    ds_read_b128 v[180:183], v230 offset:10240
    v_mfma_f32_16x16x32_bf16 v[112:115], v[208:211], v[156:159], v[112:115]
    v_mfma_f32_16x16x32_bf16 v[20:23], v[212:215], v[144:147], v[20:23]
    ds_read_b128 v[184:187], v229 offset:12288
    v_mfma_f32_16x16x32_bf16 v[52:55], v[212:215], v[148:151], v[52:55]
    v_mfma_f32_16x16x32_bf16 v[84:87], v[212:215], v[152:155], v[84:87]
    ds_read_b128 v[188:191], v230 offset:14336
    v_mfma_f32_16x16x32_bf16 v[116:119], v[212:215], v[156:159], v[116:119]
    s_add_u32 s32, s32, 1
    v_mfma_f32_16x16x32_bf16 v[24:27], v[216:219], v[144:147], v[24:27]
    s_add_u32 s46, s46, 1
    v_mfma_f32_16x16x32_bf16 v[56:59], v[216:219], v[148:151], v[56:59]
    s_cmp_eq_u32 s46, 3
    v_mfma_f32_16x16x32_bf16 v[88:91], v[216:219], v[152:155], v[88:91]
    s_cselect_b32 s36, s45, s44
    v_mfma_f32_16x16x32_bf16 v[120:123], v[216:219], v[156:159], v[120:123]
    s_cselect_b32 s46, 0, s46
    v_mfma_f32_16x16x32_bf16 v[28:31], v[220:223], v[144:147], v[28:31]
    v_mfma_f32_16x16x32_bf16 v[60:63], v[220:223], v[148:151], v[60:63]
    v_mfma_f32_16x16x32_bf16 v[92:95], v[220:223], v[152:155], v[92:95]
    v_mfma_f32_16x16x32_bf16 v[124:127], v[220:223], v[156:159], v[124:127]
    s_waitcnt lgkmcnt(0)
    v_mfma_f32_16x16x32_bf16 v[0:3], v[160:163], v[128:131], v[0:3]
    ds_read_b128 v[192:195], v231 offset:0
    v_mfma_f32_16x16x32_bf16 v[32:35], v[160:163], v[132:135], v[32:35]
    v_mfma_f32_16x16x32_bf16 v[64:67], v[160:163], v[136:139], v[64:67]
    ds_read_b128 v[144:147], v226 offset:0
    v_mfma_f32_16x16x32_bf16 v[96:99], v[160:163], v[140:143], v[96:99]
    v_mfma_f32_16x16x32_bf16 v[4:7], v[164:167], v[128:131], v[4:7]
    ds_read_b128 v[196:199], v232 offset:2048
    v_mfma_f32_16x16x32_bf16 v[36:39], v[164:167], v[132:135], v[36:39]
    v_mfma_f32_16x16x32_bf16 v[68:71], v[164:167], v[136:139], v[68:71]
    ds_read_b128 v[148:151], v226 offset:2048
    v_mfma_f32_16x16x32_bf16 v[100:103], v[164:167], v[140:143], v[100:103]
    v_mfma_f32_16x16x32_bf16 v[8:11], v[168:171], v[128:131], v[8:11]
    ds_read_b128 v[200:203], v231 offset:4096
    v_mfma_f32_16x16x32_bf16 v[40:43], v[168:171], v[132:135], v[40:43]
    v_mfma_f32_16x16x32_bf16 v[72:75], v[168:171], v[136:139], v[72:75]
    ds_read_b128 v[152:155], v226 offset:4096
    v_mfma_f32_16x16x32_bf16 v[104:107], v[168:171], v[140:143], v[104:107]
    v_mfma_f32_16x16x32_bf16 v[12:15], v[172:175], v[128:131], v[12:15]
    ds_read_b128 v[204:207], v232 offset:6144
    v_mfma_f32_16x16x32_bf16 v[44:47], v[172:175], v[132:135], v[44:47]
    v_mfma_f32_16x16x32_bf16 v[76:79], v[172:175], v[136:139], v[76:79]
    ds_read_b128 v[156:159], v226 offset:6144
    v_mfma_f32_16x16x32_bf16 v[108:111], v[172:175], v[140:143], v[108:111]
    v_mfma_f32_16x16x32_bf16 v[16:19], v[176:179], v[128:131], v[16:19]
    ds_read_b128 v[208:211], v231 offset:8192
    v_mfma_f32_16x16x32_bf16 v[48:51], v[176:179], v[132:135], v[48:51]
    v_mfma_f32_16x16x32_bf16 v[80:83], v[176:179], v[136:139], v[80:83]
    ds_read_b128 v[212:215], v232 offset:10240
    v_mfma_f32_16x16x32_bf16 v[112:115], v[176:179], v[140:143], v[112:115]
    v_mfma_f32_16x16x32_bf16 v[20:23], v[180:183], v[128:131], v[20:23]
    ds_read_b128 v[216:219], v231 offset:12288
    v_mfma_f32_16x16x32_bf16 v[52:55], v[180:183], v[132:135], v[52:55]
    v_mfma_f32_16x16x32_bf16 v[84:87], v[180:183], v[136:139], v[84:87]
    ds_read_b128 v[220:223], v232 offset:14336
    v_mfma_f32_16x16x32_bf16 v[116:119], v[180:183], v[140:143], v[116:119]
    v_add_u32 v225, s36, v225
    v_mfma_f32_16x16x32_bf16 v[24:27], v[184:187], v[128:131], v[24:27]
    v_add_u32 v226, s36, v226
    v_mfma_f32_16x16x32_bf16 v[56:59], v[184:187], v[132:135], v[56:59]
    v_add_u32 v229, s36, v229
    v_mfma_f32_16x16x32_bf16 v[88:91], v[184:187], v[136:139], v[88:91]
    v_add_u32 v230, s36, v230
    v_mfma_f32_16x16x32_bf16 v[120:123], v[184:187], v[140:143], v[120:123]
    v_add_u32 v231, s36, v231
    v_mfma_f32_16x16x32_bf16 v[28:31], v[188:191], v[128:131], v[28:31]
    v_add_u32 v232, s36, v232
    v_mfma_f32_16x16x32_bf16 v[60:63], v[188:191], v[132:135], v[60:63]
    s_cmp_lt_u32 s32, 16
    v_mfma_f32_16x16x32_bf16 v[92:95], v[188:191], v[136:139], v[92:95]
    s_waitcnt lgkmcnt(0)
    v_mfma_f32_16x16x32_bf16 v[124:127], v[188:191], v[140:143], v[124:127]
    s_cbranch_scc1 L_cloop
    v_mfma_f32_16x16x32_bf16 v[0:3], v[192:195], v[144:147], v[0:3]
    v_mfma_f32_16x16x32_bf16 v[4:7], v[196:199], v[144:147], v[4:7]
    v_mfma_f32_16x16x32_bf16 v[8:11], v[200:203], v[144:147], v[8:11]
    v_mfma_f32_16x16x32_bf16 v[12:15], v[204:207], v[144:147], v[12:15]
    v_mfma_f32_16x16x32_bf16 v[16:19], v[208:211], v[144:147], v[16:19]
    v_mfma_f32_16x16x32_bf16 v[20:23], v[212:215], v[144:147], v[20:23]
    v_mfma_f32_16x16x32_bf16 v[24:27], v[216:219], v[144:147], v[24:27]
    v_mfma_f32_16x16x32_bf16 v[28:31], v[220:223], v[144:147], v[28:31]
    v_mfma_f32_16x16x32_bf16 v[32:35], v[192:195], v[148:151], v[32:35]
    v_mfma_f32_16x16x32_bf16 v[36:39], v[196:199], v[148:151], v[36:39]
    v_mfma_f32_16x16x32_bf16 v[40:43], v[200:203], v[148:151], v[40:43]
    v_mfma_f32_16x16x32_bf16 v[44:47], v[204:207], v[148:151], v[44:47]
    v_mfma_f32_16x16x32_bf16 v[48:51], v[208:211], v[148:151], v[48:51]
    v_mfma_f32_16x16x32_bf16 v[52:55], v[212:215], v[148:151], v[52:55]
    v_mfma_f32_16x16x32_bf16 v[56:59], v[216:219], v[148:151], v[56:59]
    v_mfma_f32_16x16x32_bf16 v[60:63], v[220:223], v[148:151], v[60:63]
    v_mfma_f32_16x16x32_bf16 v[64:67], v[192:195], v[152:155], v[64:67]
    v_cvt_pk_bf16_f32 v128, v0, v1
    v_cvt_pk_bf16_f32 v129, v2, v3
    v_cvt_pk_bf16_f32 v130, v4, v5
    v_mfma_f32_16x16x32_bf16 v[68:71], v[196:199], v[152:155], v[68:71]
    v_cvt_pk_bf16_f32 v131, v6, v7
    ds_write_b128 v236, v[128:131] offset:0
    v_cvt_pk_bf16_f32 v132, v8, v9
    v_mfma_f32_16x16x32_bf16 v[72:75], v[200:203], v[152:155], v[72:75]
    v_cvt_pk_bf16_f32 v133, v10, v11
    v_cvt_pk_bf16_f32 v134, v12, v13
    v_cvt_pk_bf16_f32 v135, v14, v15
    v_mfma_f32_16x16x32_bf16 v[76:79], v[204:207], v[152:155], v[76:79]
    ds_write_b128 v237, v[132:135] offset:0
    v_cvt_pk_bf16_f32 v136, v16, v17
    v_cvt_pk_bf16_f32 v137, v18, v19
    v_mfma_f32_16x16x32_bf16 v[80:83], v[208:211], v[152:155], v[80:83]
    v_cvt_pk_bf16_f32 v138, v20, v21
    v_cvt_pk_bf16_f32 v139, v22, v23
    ds_write_b128 v236, v[136:139] offset:128
    v_mfma_f32_16x16x32_bf16 v[84:87], v[212:215], v[152:155], v[84:87]
    v_cvt_pk_bf16_f32 v140, v24, v25
    v_cvt_pk_bf16_f32 v141, v26, v27
    v_cvt_pk_bf16_f32 v142, v28, v29
    v_mfma_f32_16x16x32_bf16 v[88:91], v[216:219], v[152:155], v[88:91]
    v_cvt_pk_bf16_f32 v143, v30, v31
    ds_write_b128 v237, v[140:143] offset:128
    v_mfma_f32_16x16x32_bf16 v[92:95], v[220:223], v[152:155], v[92:95]
    v_mfma_f32_16x16x32_bf16 v[96:99], v[192:195], v[156:159], v[96:99]
    v_cvt_pk_bf16_f32 v160, v32, v33
    v_cvt_pk_bf16_f32 v161, v34, v35
    v_cvt_pk_bf16_f32 v162, v36, v37
    v_mfma_f32_16x16x32_bf16 v[100:103], v[196:199], v[156:159], v[100:103]
    v_cvt_pk_bf16_f32 v163, v38, v39
    ds_write_b128 v236, v[160:163] offset:4096
    v_cvt_pk_bf16_f32 v164, v40, v41
    v_mfma_f32_16x16x32_bf16 v[104:107], v[200:203], v[156:159], v[104:107]
    v_cvt_pk_bf16_f32 v165, v42, v43
    v_cvt_pk_bf16_f32 v166, v44, v45
    v_cvt_pk_bf16_f32 v167, v46, v47
    v_mfma_f32_16x16x32_bf16 v[108:111], v[204:207], v[156:159], v[108:111]
    ds_write_b128 v237, v[164:167] offset:4096
    v_cvt_pk_bf16_f32 v168, v48, v49
    v_cvt_pk_bf16_f32 v169, v50, v51
    v_mfma_f32_16x16x32_bf16 v[112:115], v[208:211], v[156:159], v[112:115]
    v_cvt_pk_bf16_f32 v170, v52, v53
    v_cvt_pk_bf16_f32 v171, v54, v55
    ds_write_b128 v236, v[168:171] offset:4224
    v_mfma_f32_16x16x32_bf16 v[116:119], v[212:215], v[156:159], v[116:119]
    v_cvt_pk_bf16_f32 v172, v56, v57
    v_cvt_pk_bf16_f32 v173, v58, v59
    v_cvt_pk_bf16_f32 v174, v60, v61
    v_mfma_f32_16x16x32_bf16 v[120:123], v[216:219], v[156:159], v[120:123]
    v_cvt_pk_bf16_f32 v175, v62, v63
    ds_write_b128 v237, v[172:175] offset:4224
    ds_read_b128 v[0:3], v242 offset:0
    v_mfma_f32_16x16x32_bf16 v[124:127], v[220:223], v[156:159], v[124:127]
    ds_read_b128 v[4:7], v243 offset:1024
    ds_read_b128 v[8:11], v242 offset:2048
    ds_read_b128 v[12:15], v243 offset:3072
    v_cvt_pk_bf16_f32 v176, v64, v65
    v_cvt_pk_bf16_f32 v177, v66, v67
    v_cvt_pk_bf16_f32 v178, v68, v69
    v_cvt_pk_bf16_f32 v179, v70, v71
    ds_write_b128 v236, v[176:179] offset:8192
    v_cvt_pk_bf16_f32 v180, v72, v73
    v_cvt_pk_bf16_f32 v181, v74, v75
    v_cvt_pk_bf16_f32 v182, v76, v77
    v_cvt_pk_bf16_f32 v183, v78, v79
    ds_write_b128 v237, v[180:183] offset:8192
    v_cvt_pk_bf16_f32 v184, v80, v81
    v_cvt_pk_bf16_f32 v185, v82, v83
    v_cvt_pk_bf16_f32 v186, v84, v85
    v_cvt_pk_bf16_f32 v187, v86, v87
    ds_write_b128 v236, v[184:187] offset:8320
    v_cvt_pk_bf16_f32 v188, v88, v89
    v_cvt_pk_bf16_f32 v189, v90, v91
    v_cvt_pk_bf16_f32 v190, v92, v93
    v_cvt_pk_bf16_f32 v191, v94, v95
    ds_write_b128 v237, v[188:191] offset:8320
    ds_read_b128 v[32:35], v242 offset:4096
    ds_read_b128 v[36:39], v243 offset:5120
    ds_read_b128 v[40:43], v242 offset:6144
    ds_read_b128 v[44:47], v243 offset:7168
    s_waitcnt lgkmcnt(11)
    buffer_store_dwordx4 v[0:3], v244, s[24:27], s42 offen nt
    s_add_u32 s42, s42, 28672
    s_waitcnt lgkmcnt(10)
    buffer_store_dwordx4 v[4:7], v244, s[24:27], s42 offen nt
    s_add_u32 s42, s42, 28672
    s_waitcnt lgkmcnt(9)
    buffer_store_dwordx4 v[8:11], v244, s[24:27], s42 offen nt
    s_add_u32 s42, s42, 28672
    s_waitcnt lgkmcnt(8)
    buffer_store_dwordx4 v[12:15], v244, s[24:27], s42 offen nt
    s_add_u32 s42, s42, 28672
    v_cvt_pk_bf16_f32 v128, v96, v97
    v_cvt_pk_bf16_f32 v129, v98, v99
    v_cvt_pk_bf16_f32 v130, v100, v101
    v_cvt_pk_bf16_f32 v131, v102, v103
    ds_write_b128 v236, v[128:131] offset:12288
    v_cvt_pk_bf16_f32 v132, v104, v105
    v_cvt_pk_bf16_f32 v133, v106, v107
    v_cvt_pk_bf16_f32 v134, v108, v109
    v_cvt_pk_bf16_f32 v135, v110, v111
    ds_write_b128 v237, v[132:135] offset:12288
    v_cvt_pk_bf16_f32 v136, v112, v113
    v_cvt_pk_bf16_f32 v137, v114, v115
    v_cvt_pk_bf16_f32 v138, v116, v117
    v_cvt_pk_bf16_f32 v139, v118, v119
    ds_write_b128 v236, v[136:139] offset:12416
    v_cvt_pk_bf16_f32 v140, v120, v121
    v_cvt_pk_bf16_f32 v141, v122, v123
    v_cvt_pk_bf16_f32 v142, v124, v125
    v_cvt_pk_bf16_f32 v143, v126, v127
    ds_write_b128 v237, v[140:143] offset:12416
    ds_read_b128 v[64:67], v242 offset:8192
    ds_read_b128 v[68:71], v243 offset:9216
    ds_read_b128 v[72:75], v242 offset:10240
    ds_read_b128 v[76:79], v243 offset:11264
    s_waitcnt lgkmcnt(11)
    buffer_store_dwordx4 v[32:35], v244, s[24:27], s42 offen nt
    s_add_u32 s42, s42, 28672
    s_waitcnt lgkmcnt(10)
    buffer_store_dwordx4 v[36:39], v244, s[24:27], s42 offen nt
    s_add_u32 s42, s42, 28672
    s_waitcnt lgkmcnt(9)
    buffer_store_dwordx4 v[40:43], v244, s[24:27], s42 offen nt
    s_add_u32 s42, s42, 28672
    s_waitcnt lgkmcnt(8)
    buffer_store_dwordx4 v[44:47], v244, s[24:27], s42 offen nt
    s_add_u32 s42, s42, 28672
    ds_read_b128 v[96:99], v242 offset:12288
    ds_read_b128 v[100:103], v243 offset:13312
    ds_read_b128 v[104:107], v242 offset:14336
    ds_read_b128 v[108:111], v243 offset:15360
    s_waitcnt lgkmcnt(7)
    buffer_store_dwordx4 v[64:67], v244, s[24:27], s42 offen nt
    s_add_u32 s42, s42, 28672
    s_waitcnt lgkmcnt(6)
    buffer_store_dwordx4 v[68:71], v244, s[24:27], s42 offen nt
    s_add_u32 s42, s42, 28672
    s_waitcnt lgkmcnt(5)
    buffer_store_dwordx4 v[72:75], v244, s[24:27], s42 offen nt
    s_add_u32 s42, s42, 28672
    s_waitcnt lgkmcnt(4)
    buffer_store_dwordx4 v[76:79], v244, s[24:27], s42 offen nt
    s_add_u32 s42, s42, 28672
    s_waitcnt lgkmcnt(3)
    buffer_store_dwordx4 v[96:99], v244, s[24:27], s42 offen nt
    s_add_u32 s42, s42, 28672
    s_waitcnt lgkmcnt(2)
    buffer_store_dwordx4 v[100:103], v244, s[24:27], s42 offen nt
    s_add_u32 s42, s42, 28672
    s_waitcnt lgkmcnt(1)
    buffer_store_dwordx4 v[104:107], v244, s[24:27], s42 offen nt
    s_add_u32 s42, s42, 28672
    s_waitcnt lgkmcnt(0)
    buffer_store_dwordx4 v[108:111], v244, s[24:27], s42 offen nt
    s_add_u32 s42, s42, 28672
    s_endpgm
.section .rodata,"a"
.p2align 6
.amdhsa_kernel standalone__weight_only_int_omniquant__prompt_kernel
  .amdhsa_next_free_vgpr 256
  .amdhsa_next_free_sgpr 102
  .amdhsa_accum_offset 256
  .amdhsa_group_segment_fixed_size 0
  .amdhsa_kernarg_size 64
  .amdhsa_user_sgpr_count 2
  .amdhsa_user_sgpr_kernarg_segment_ptr 1
  .amdhsa_system_sgpr_workgroup_id_x 1
.end_amdhsa_kernel
```
